```python
import torch

def _softmax(x, axis=-1):
    return torch.softmax(x, dim=axis)
def _gelu(x):
    return torch.nn.functional.gelu(x, approximate="tanh")
def _silu(x):
    return torch.nn.functional.silu(x)
def _sigmoid(x):
    return torch.sigmoid(x)
def _layernorm(x, axis=-1, eps=1e-5):
    m = x.mean(dim=axis, keepdim=True)
    v = x.var(dim=axis, keepdim=True, unbiased=False)
    return (x - m) / torch.sqrt(v + eps)
def _scatter_add(tgt, idx, src, axis=0):
    return tgt.clone().index_add_(axis, idx, src)
def _segment_sum(src, seg, n):
    out = torch.zeros((n,) + src.shape[1:], dtype=src.dtype)
    return out.index_add_(0, seg, src)
def _pad(x, pw):
    flat = tuple(v for pair in reversed(pw) for v in pair)
    return torch.nn.functional.pad(x, flat)

kernel_name = 'standalone__linear_attn_block__prompt'

def setup_inputs():

    _w = (lambda a: (lambda t: t.to(torch.bfloat16) if t.is_floating_point() else t)(torch.as_tensor(a)))
    B, S, D = 1, 2048, 576
    return {
        "x": _w((lambda *s: torch.randn(*s, dtype=torch.bfloat16) * 0.05)(B, S, D)),
        "wqkv": _w((lambda *s: torch.randn(*s, dtype=torch.bfloat16) * 0.4)(D, 3 * D)),
        "wo": _w((lambda *s: torch.randn(*s, dtype=torch.bfloat16) * 0.05)(D, D)),
    }

def reference(x, wqkv, wo):
    B, S, D = x.shape
    H = 32; Dh = D // H
    qkv = (lambda x, *d: x.permute(*d))((x @ wqkv).reshape(B, S, 3, H, Dh), 2, 0, 3, 1, 4)
    q, k, v = qkv[0], qkv[1], qkv[2]
    phi = lambda t: torch.where(t > 0, t + 1, torch.exp(t)) + 1e-6
    pq, pk = phi(q), phi(k)
    kv = torch.einsum("bhsd,bhse->bhde", pk, v)
    z = torch.einsum("bhsd->bhd", pk)
    num = torch.einsum("bhqd,bhde->bhqe", pq, kv)
    den = torch.einsum("bhqd,bhd->bhq", pq, z)[..., None] + 1e-6
    o = num / den
    return (lambda x, *d: x.permute(*d))(o, 0, 2, 1, 3).reshape(B, S, D) @ wo
```

```asm
; @launch grid=(256,1,1) block=(512,1,1) lds=163840
.amdgcn_target "amdgcn-amd-amdhsa--gfx950"
.text
.globl standalone__linear_attn_block__prompt_kernel
.p2align 8
.type standalone__linear_attn_block__prompt_kernel,@function
standalone__linear_attn_block__prompt_kernel:
  s_cmp_ge_u32 s2, 256
  s_cbranch_scc1 L_end
  s_load_dwordx4 s[4:7], s[0:1], 0
  s_load_dwordx4 s[12:15], s[0:1], 32
  s_load_dwordx4 s[8:11], s[0:1], 16
  v_lshrrev_b32 v2, 6, v0
  v_and_b32 v1, 63, v0
  s_and_b32 s46, s2, 7
  v_readfirstlane_b32 s39, v2
  s_lshr_b32 s47, s2, 3
  s_and_b32 s48, s47, 3
  s_lshr_b32 s49, s47, 2
  s_lshr_b32 s36, s46, 1
  s_lshl_b32 s36, s36, 2
  s_add_u32 s36, s36, s48
  s_and_b32 s37, s46, 1
  s_lshl_b32 s37, s37, 3
  s_add_u32 s37, s37, s49
  s_xor_b32 s38, s37, 1
  s_add_u32 s40, s48, s49
  s_mul_i32 s46, s40, 13
  s_lshr_b32 s46, s46, 6
  s_mul_i32 s46, s46, 5
  s_sub_u32 s40, s40, s46
  s_lshl_b32 s40, s40, 1
  s_cmp_eq_u32 s37, 15
  s_cselect_b32 s43, 8, 0
  s_cmp_eq_u32 s38, 15
  s_cselect_b32 s44, 8, 0
  s_cmp_lg_u32 s39, 4
  s_cbranch_scc1 L_nocpf
  s_getpc_b64 s[48:49]
L_pcref:
  s_lshr_b32 s46, s2, 3
  s_mul_i32 s46, s46, 768
  s_sub_u32 s48, s48, L_pcref-standalone__linear_attn_block__prompt_kernel
  s_subb_u32 s49, s49, 0
  v_lshlrev_b32 v2, 7, v1
  v_add_u32 v2, s46, v2
  v_min_u32 v2, L_end-standalone__linear_attn_block__prompt_kernel, v2
  s_mov_b64 exec, 0x3f
  global_load_dword v255, v2, s[48:49]
  s_mov_b64 exec, -1
L_nocpf:
  s_cmp_ge_u32 s39, 4
  s_cbranch_scc1 L_compute
L_loader:
  s_mov_b32 s45, s39
  v_lshrrev_b32 v2, 3, v1
  v_mul_u32_u24 v2, 1152, v2
  v_and_b32 v3, 7, v1
  v_lshrrev_b32 v12, 4, v1
  v_xor_b32 v3, v3, v12
  v_lshlrev_b32 v3, 4, v3
  v_add_u32 v4, v2, v3
  v_xor_b32 v5, 64, v4
  v_mov_b32 v20, 1073741824
  s_lshl_b32 s46, s45, 6
  v_add_u32 v21, s46, v1
  s_mul_i32 s51, s36, 147456
  s_mul_i32 s46, s45, 36864
  s_add_u32 s51, s51, s46
  s_mul_i32 s52, s37, 72
  s_sub_u32 s52, s52, s43
  s_mov_b32 s53, s40
  s_lshl_b32 s54, s45, 12
  s_lshl_b32 s55, s45, 10
  s_waitcnt lgkmcnt(0)
  s_mov_b32 s16, s4
  s_and_b32 s17, s5, 0xffff
  s_mov_b32 s18, 2359296
  s_mov_b32 s19, 0x00020000
  s_lshl_b32 s46, s53, 7
  s_add_u32 s46, s46, s51
  s_add_u32 m0, s54, 0
  s_nop 0
  buffer_load_dwordx4 v4, s[16:19], s46 offen lds
  s_add_u32 m0, s54, 1024
  s_add_u32 s48, s46, 9216
  buffer_load_dwordx4 v5, s[16:19], s48 offen lds
  s_add_u32 m0, s54, 2048
  s_add_u32 s48, s46, 18432
  buffer_load_dwordx4 v4, s[16:19], s48 offen lds
  s_add_u32 m0, s54, 3072
  s_add_u32 s48, s46, 27648
  buffer_load_dwordx4 v5, s[16:19], s48 offen lds
  s_add_u32 s94, s55, 57344
  s_cmp_eq_u32 s45, 3
  s_cselect_b32 s94, 108544, s94
  s_add_u32 s95, s55, 68608
  s_cmp_eq_u32 s45, 3
  s_cselect_b32 s95, 108544, s95
  s_add_u32 s96, s55, 79872
  s_cmp_eq_u32 s45, 3
  s_cselect_b32 s96, 108544, s96
  s_mov_b32 s20, s6
  s_and_b32 s21, s7, 0xffff
  s_mov_b32 s22, 1990656
  s_mov_b32 s23, 0x00020000
  v_add_u32 v12, 0, v21
  v_mul_u32_u24 v13, 745, v12
  v_lshrrev_b32 v13, 16, v13
  v_mul_u32_u24 v14, 88, v13
  v_sub_u32 v14, v12, v14
  v_mul_u32_u24 v15, 6554, v14
  v_lshrrev_b32 v15, 16, v15
  v_mul_u32_u24 v16, 10, v15
  v_sub_u32 v16, v14, v16
  v_cmp_le_u32 vcc, 5, v16
  v_lshlrev_b32 v17, 3, v13
  v_add_u32 v17, v17, v15
  v_cndmask_b32 v18, 0, 1, vcc
  v_mul_u32_u24 v19, 5, v18
  v_sub_u32 v16, v16, v19
  v_lshlrev_b32 v16, 4, v16
  v_mul_u32_u24 v17, 3456, v17
  v_mul_u32_u24 v19, 1152, v18
  v_add3_u32 v17, v17, v19, v16
  v_cmp_gt_u32 vcc, 80, v14
  v_cmp_gt_u32 s[46:47], 8, v13
  v_add_u32 v17, 1152, v17
  s_and_b64 vcc, vcc, s[46:47]
  s_nop 0
  v_cndmask_b32 v6, v20, v17, vcc
  s_mul_i32 s47, s53, 221184
  s_add_u32 s47, s47, s52
  s_add_u32 m0, s55, 49152
  s_nop 0
  buffer_load_dwordx4 v6, s[20:23], s47 offen lds
  v_add_u32 v12, 256, v21
  v_mul_u32_u24 v13, 745, v12
  v_lshrrev_b32 v13, 16, v13
  v_mul_u32_u24 v14, 88, v13
  v_sub_u32 v14, v12, v14
  v_mul_u32_u24 v15, 6554, v14
  v_lshrrev_b32 v15, 16, v15
  v_mul_u32_u24 v16, 10, v15
  v_sub_u32 v16, v14, v16
  v_cmp_le_u32 vcc, 5, v16
  v_lshlrev_b32 v17, 3, v13
  v_add_u32 v17, v17, v15
  v_cndmask_b32 v18, 0, 1, vcc
  v_mul_u32_u24 v19, 5, v18
  v_sub_u32 v16, v16, v19
  v_lshlrev_b32 v16, 4, v16
  v_mul_u32_u24 v17, 3456, v17
  v_mul_u32_u24 v19, 1152, v18
  v_add3_u32 v17, v17, v19, v16
  v_cmp_gt_u32 vcc, 80, v14
  v_cmp_gt_u32 s[46:47], 8, v13
  v_add_u32 v17, 1152, v17
  s_and_b64 vcc, vcc, s[46:47]
  s_nop 0
  v_cndmask_b32 v7, v20, v17, vcc
  s_mul_i32 s47, s53, 221184
  s_add_u32 s47, s47, s52
  s_add_u32 m0, s55, 53248
  s_nop 0
  buffer_load_dwordx4 v7, s[20:23], s47 offen lds
  v_add_u32 v12, 512, v21
  v_mul_u32_u24 v13, 745, v12
  v_lshrrev_b32 v13, 16, v13
  v_mul_u32_u24 v14, 88, v13
  v_sub_u32 v14, v12, v14
  v_mul_u32_u24 v15, 6554, v14
  v_lshrrev_b32 v15, 16, v15
  v_mul_u32_u24 v16, 10, v15
  v_sub_u32 v16, v14, v16
  v_cmp_le_u32 vcc, 5, v16
  v_lshlrev_b32 v17, 3, v13
  v_add_u32 v17, v17, v15
  v_cndmask_b32 v18, 0, 1, vcc
  v_mul_u32_u24 v19, 5, v18
  v_sub_u32 v16, v16, v19
  v_lshlrev_b32 v16, 4, v16
  v_mul_u32_u24 v17, 3456, v17
  v_mul_u32_u24 v19, 1152, v18
  v_add3_u32 v17, v17, v19, v16
  v_cmp_gt_u32 vcc, 80, v14
  v_cmp_gt_u32 s[46:47], 8, v13
  v_add_u32 v17, 1152, v17
  s_and_b64 vcc, vcc, s[46:47]
  s_nop 0
  v_cndmask_b32 v8, v20, v17, vcc
  s_mul_i32 s47, s53, 221184
  s_add_u32 s47, s47, s52
  s_mov_b32 m0, s94
  s_nop 0
  buffer_load_dwordx4 v8, s[20:23], s47 offen lds
  s_add_u32 s53, s53, 1
  s_cmp_eq_u32 s53, 9
  s_cselect_b32 s53, 0, s53
  s_lshl_b32 s46, s53, 7
  s_add_u32 s46, s46, s51
  s_add_u32 m0, s54, 16384
  s_nop 0
  buffer_load_dwordx4 v4, s[16:19], s46 offen lds
  s_add_u32 m0, s54, 17408
  s_add_u32 s48, s46, 9216
  buffer_load_dwordx4 v5, s[16:19], s48 offen lds
  s_add_u32 m0, s54, 18432
  s_add_u32 s48, s46, 18432
  buffer_load_dwordx4 v4, s[16:19], s48 offen lds
  s_add_u32 m0, s54, 19456
  s_add_u32 s48, s46, 27648
  buffer_load_dwordx4 v5, s[16:19], s48 offen lds
  s_mul_i32 s47, s53, 221184
  s_add_u32 s47, s47, s52
  s_add_u32 m0, s55, 60416
  s_nop 0
  buffer_load_dwordx4 v6, s[20:23], s47 offen lds
  s_add_u32 m0, s55, 64512
  s_nop 0
  buffer_load_dwordx4 v7, s[20:23], s47 offen lds
  s_mov_b32 m0, s95
  s_nop 0
  buffer_load_dwordx4 v8, s[20:23], s47 offen lds
  s_add_u32 s53, s53, 1
  s_cmp_eq_u32 s53, 9
  s_cselect_b32 s53, 0, s53
  s_mov_b32 s24, s8
  s_and_b32 s25, s9, 0xffff
  s_mov_b32 s26, 663552
  s_mov_b32 s27, 0x00020000
  s_mov_b32 s32, s14
  s_and_b32 s33, s15, 0xffff
  s_mov_b32 s34, 268435456
  s_mov_b32 s35, 0x00020000
  s_load_dword s42, s[14:15], 0
  v_add_u32 v12, 0, v21
  v_mul_u32_u24 v13, 745, v12
  v_lshrrev_b32 v13, 16, v13
  v_mul_u32_u24 v14, 88, v13
  v_sub_u32 v14, v12, v14
  v_mul_u32_u24 v15, 6554, v14
  v_lshrrev_b32 v15, 16, v15
  v_mul_u32_u24 v16, 10, v15
  v_sub_u32 v16, v14, v16
  v_cmp_le_u32 vcc, 5, v16
  v_lshrrev_b32 v19, 2, v13
  v_and_b32 v22, 3, v13
  v_cndmask_b32 v18, 0, 1, vcc
  v_mul_u32_u24 v17, 5, v18
  v_sub_u32 v16, v16, v17
  v_lshlrev_b32 v16, 4, v16
  v_lshlrev_b32 v19, 6, v19
  v_lshlrev_b32 v22, 3, v22
  v_lshlrev_b32 v18, 5, v18
  v_add3_u32 v19, v19, v22, v18
  v_add_u32 v19, v19, v15
  v_cmp_gt_u32 vcc, 80, v14
  v_cmp_gt_u32 s[46:47], 8, v13
  v_mul_u32_u24 v19, 3456, v19
  v_add_u32 v19, v19, v16
  s_and_b64 vcc, vcc, s[46:47]
  s_nop 0
  v_cndmask_b32 v9, v20, v19, vcc
  v_add_u32 v12, 256, v21
  v_mul_u32_u24 v13, 745, v12
  v_lshrrev_b32 v13, 16, v13
  v_mul_u32_u24 v14, 88, v13
  v_sub_u32 v14, v12, v14
  v_mul_u32_u24 v15, 6554, v14
  v_lshrrev_b32 v15, 16, v15
  v_mul_u32_u24 v16, 10, v15
  v_sub_u32 v16, v14, v16
  v_cmp_le_u32 vcc, 5, v16
  v_lshrrev_b32 v19, 2, v13
  v_and_b32 v22, 3, v13
  v_cndmask_b32 v18, 0, 1, vcc
  v_mul_u32_u24 v17, 5, v18
  v_sub_u32 v16, v16, v17
  v_lshlrev_b32 v16, 4, v16
  v_lshlrev_b32 v19, 6, v19
  v_lshlrev_b32 v22, 3, v22
  v_lshlrev_b32 v18, 5, v18
  v_add3_u32 v19, v19, v22, v18
  v_add_u32 v19, v19, v15
  v_cmp_gt_u32 vcc, 80, v14
  v_cmp_gt_u32 s[46:47], 8, v13
  v_mul_u32_u24 v19, 3456, v19
  v_add_u32 v19, v19, v16
  s_and_b64 vcc, vcc, s[46:47]
  s_nop 0
  v_cndmask_b32 v10, v20, v19, vcc
  v_add_u32 v12, 512, v21
  v_mul_u32_u24 v13, 745, v12
  v_lshrrev_b32 v13, 16, v13
  v_mul_u32_u24 v14, 88, v13
  v_sub_u32 v14, v12, v14
  v_mul_u32_u24 v15, 6554, v14
  v_lshrrev_b32 v15, 16, v15
  v_mul_u32_u24 v16, 10, v15
  v_sub_u32 v16, v14, v16
  v_cmp_le_u32 vcc, 5, v16
  v_lshrrev_b32 v19, 2, v13
  v_and_b32 v22, 3, v13
  v_cndmask_b32 v18, 0, 1, vcc
  v_mul_u32_u24 v17, 5, v18
  v_sub_u32 v16, v16, v17
  v_lshlrev_b32 v16, 4, v16
  v_lshlrev_b32 v19, 6, v19
  v_lshlrev_b32 v22, 3, v22
  v_lshlrev_b32 v18, 5, v18
  v_add3_u32 v19, v19, v22, v18
  v_add_u32 v19, v19, v15
  v_cmp_gt_u32 vcc, 80, v14
  v_cmp_gt_u32 s[46:47], 8, v13
  v_mul_u32_u24 v19, 3456, v19
  v_add_u32 v19, v19, v16
  s_and_b64 vcc, vcc, s[46:47]
  s_nop 0
  v_cndmask_b32 v11, v20, v19, vcc
  v_add_u32 v12, 0, v1
  v_mul_u32_u24 v13, 6554, v12
  v_lshrrev_b32 v13, 16, v13
  v_mul_u32_u24 v14, 10, v13
  v_sub_u32 v14, v12, v14
  v_mul_u32_u24 v13, 1152, v13
  v_lshlrev_b32 v15, 4, v14
  v_add_u32 v13, v13, v15
  v_cmp_gt_u32 vcc, 9, v14
  s_nop 1
  v_cndmask_b32 v52, v20, v13, vcc
  v_add_u32 v12, 64, v1
  v_mul_u32_u24 v13, 6554, v12
  v_lshrrev_b32 v13, 16, v13
  v_mul_u32_u24 v14, 10, v13
  v_sub_u32 v14, v12, v14
  v_mul_u32_u24 v13, 1152, v13
  v_lshlrev_b32 v15, 4, v14
  v_add_u32 v13, v13, v15
  v_cmp_gt_u32 vcc, 9, v14
  s_nop 1
  v_cndmask_b32 v53, v20, v13, vcc
  v_add_u32 v12, 128, v1
  v_mul_u32_u24 v13, 6554, v12
  v_lshrrev_b32 v13, 16, v13
  v_mul_u32_u24 v14, 10, v13
  v_sub_u32 v14, v12, v14
  v_mul_u32_u24 v13, 1152, v13
  v_lshlrev_b32 v15, 4, v14
  v_add_u32 v13, v13, v15
  v_cmp_gt_u32 vcc, 9, v14
  s_nop 1
  v_cndmask_b32 v54, v20, v13, vcc
  v_add_u32 v12, 192, v1
  v_mul_u32_u24 v13, 6554, v12
  v_lshrrev_b32 v13, 16, v13
  v_mul_u32_u24 v14, 10, v13
  v_sub_u32 v14, v12, v14
  v_mul_u32_u24 v13, 1152, v13
  v_lshlrev_b32 v15, 4, v14
  v_add_u32 v13, v13, v15
  v_cmp_gt_u32 vcc, 9, v14
  s_nop 1
  v_cndmask_b32 v55, v20, v13, vcc
  v_add_u32 v12, 256, v1
  v_mul_u32_u24 v13, 6554, v12
  v_lshrrev_b32 v13, 16, v13
  v_mul_u32_u24 v14, 10, v13
  v_sub_u32 v14, v12, v14
  v_mul_u32_u24 v13, 1152, v13
  v_lshlrev_b32 v15, 4, v14
  v_add_u32 v13, v13, v15
  v_cmp_gt_u32 vcc, 9, v14
  s_nop 1
  v_cndmask_b32 v56, v20, v13, vcc
  v_mov_b32 v24, v21
  v_mov_b32 v27, 107648
  v_cmp_le_u32 vcc, 90, v24
  v_subrev_u32 v28, 90, v24
  s_nop 0
  v_cndmask_b32 v28, v24, v28, vcc
  v_cndmask_b32 v29, 0, 1, vcc
  v_mul_u32_u24 v30, 13108, v28
  v_lshrrev_b32 v30, 16, v30
  v_mul_u32_u24 v31, 5, v30
  v_sub_u32 v31, v28, v31
  v_mul_u32_u24 v32, 18, v29
  v_add_u32 v30, v30, v32
  v_lshlrev_b32 v32, 2, v29
  v_add_u32 v31, v31, v32
  v_cmp_le_u32 vcc, 180, v24
  v_subrev_u32 v32, 180, v24
  s_nop 0
  v_cndmask_b32 v31, v31, v32, vcc
  v_cmp_le_u32 s[46:47], 5, v31
  v_mov_b32 v33, 36
  v_mov_b32 v34, 37
  s_nop 0
  v_cndmask_b32 v33, v33, v34, s[46:47]
  v_cndmask_b32 v30, v30, v33, vcc
  v_cndmask_b32 v35, 0, 1, vcc
  v_and_b32 v32, 3, v31
  v_lshlrev_b32 v32, 4, v32
  v_lshrrev_b32 v33, 2, v31
  v_lshlrev_b32 v33, 3, v33
  v_add_u32 v32, v32, v33
  v_cmp_eq_u32 vcc, 8, v31
  v_mul_u32_u24 v30, 80, v30
  s_nop 0
  v_cndmask_b32 v32, v32, 64, vcc
  v_add3_u32 v25, v30, v32, 0
  v_add_u32 v25, 104448, v25
  v_add_u32 v26, 4, v25
  v_cmp_eq_u32 vcc, 4, v31
  v_cmp_eq_u32 s[46:47], 1, v35
  v_cmp_eq_u32 s[48:49], 1, v29
  s_nop 0
  s_and_b64 s[68:69], vcc, s[46:47]
  s_andn2_b64 vcc, vcc, s[46:47]
  s_and_b64 s[46:47], vcc, s[48:49]
  s_andn2_b64 s[48:49], vcc, s[48:49]
  v_add_u32 v32, 80, v26
  v_cndmask_b32 v25, v25, v27, s[46:47]
  v_cndmask_b32 v26, v26, v27, s[48:49]
  v_cndmask_b32 v26, v26, v32, s[68:69]
  v_lshlrev_b32 v28, 4, v24
  v_mov_b32 v12, 0
  v_mov_b32 v13, 0
  v_mov_b32 v14, 0
  v_mov_b32 v15, 0
  v_lshlrev_b32 v16, 4, v21
  v_add_u32 v16, 104448, v16
  ds_write_b128 v16, v[12:15]
  s_waitcnt vmcnt(7)
  s_barrier
  s_lshl_b32 s46, s53, 7
  s_add_u32 s46, s46, s51
  s_add_u32 m0, s54, 32768
  s_nop 0
  buffer_load_dwordx4 v4, s[16:19], s46 offen lds
  s_add_u32 m0, s54, 33792
  s_add_u32 s48, s46, 9216
  buffer_load_dwordx4 v5, s[16:19], s48 offen lds
  s_add_u32 m0, s54, 34816
  s_add_u32 s48, s46, 18432
  buffer_load_dwordx4 v4, s[16:19], s48 offen lds
  s_add_u32 m0, s54, 35840
  s_add_u32 s48, s46, 27648
  buffer_load_dwordx4 v5, s[16:19], s48 offen lds
  s_mul_i32 s47, s53, 221184
  s_add_u32 s47, s47, s52
  s_add_u32 m0, s55, 71680
  s_nop 0
  buffer_load_dwordx4 v6, s[20:23], s47 offen lds
  s_add_u32 m0, s55, 75776
  s_nop 0
  buffer_load_dwordx4 v7, s[20:23], s47 offen lds
  s_mov_b32 m0, s96
  s_nop 0
  buffer_load_dwordx4 v8, s[20:23], s47 offen lds
  s_add_u32 s53, s53, 1
  s_cmp_eq_u32 s53, 9
  s_cselect_b32 s53, 0, s53
  s_waitcnt vmcnt(7)
  s_barrier
  s_lshl_b32 s46, s53, 7
  s_add_u32 s46, s46, s51
  s_add_u32 m0, s54, 0
  s_nop 0
  buffer_load_dwordx4 v4, s[16:19], s46 offen lds
  s_add_u32 m0, s54, 1024
  s_add_u32 s48, s46, 9216
  buffer_load_dwordx4 v5, s[16:19], s48 offen lds
  s_add_u32 m0, s54, 2048
  s_add_u32 s48, s46, 18432
  buffer_load_dwordx4 v4, s[16:19], s48 offen lds
  s_add_u32 m0, s54, 3072
  s_add_u32 s48, s46, 27648
  buffer_load_dwordx4 v5, s[16:19], s48 offen lds
  s_mul_i32 s47, s53, 221184
  s_add_u32 s47, s47, s52
  s_add_u32 m0, s55, 49152
  s_nop 0
  buffer_load_dwordx4 v6, s[20:23], s47 offen lds
  s_add_u32 m0, s55, 53248
  s_nop 0
  buffer_load_dwordx4 v7, s[20:23], s47 offen lds
  s_mov_b32 m0, s94
  s_nop 0
  buffer_load_dwordx4 v8, s[20:23], s47 offen lds
  s_add_u32 s53, s53, 1
  s_cmp_eq_u32 s53, 9
  s_cselect_b32 s53, 0, s53
  s_waitcnt vmcnt(7)
  s_barrier
  s_lshl_b32 s46, s53, 7
  s_add_u32 s46, s46, s51
  s_add_u32 m0, s54, 16384
  s_nop 0
  buffer_load_dwordx4 v4, s[16:19], s46 offen lds
  s_add_u32 m0, s54, 17408
  s_add_u32 s48, s46, 9216
  buffer_load_dwordx4 v5, s[16:19], s48 offen lds
  s_add_u32 m0, s54, 18432
  s_add_u32 s48, s46, 18432
  buffer_load_dwordx4 v4, s[16:19], s48 offen lds
  s_add_u32 m0, s54, 19456
  s_add_u32 s48, s46, 27648
  buffer_load_dwordx4 v5, s[16:19], s48 offen lds
  s_mul_i32 s47, s53, 221184
  s_add_u32 s47, s47, s52
  s_add_u32 m0, s55, 60416
  s_nop 0
  buffer_load_dwordx4 v6, s[20:23], s47 offen lds
  s_add_u32 m0, s55, 64512
  s_nop 0
  buffer_load_dwordx4 v7, s[20:23], s47 offen lds
  s_mov_b32 m0, s95
  s_nop 0
  buffer_load_dwordx4 v8, s[20:23], s47 offen lds
  s_add_u32 s53, s53, 1
  s_cmp_eq_u32 s53, 9
  s_cselect_b32 s53, 0, s53
  s_waitcnt vmcnt(7)
  s_barrier
  s_lshl_b32 s46, s53, 7
  s_add_u32 s46, s46, s51
  s_add_u32 m0, s54, 32768
  s_nop 0
  buffer_load_dwordx4 v4, s[16:19], s46 offen lds
  s_add_u32 m0, s54, 33792
  s_add_u32 s48, s46, 9216
  buffer_load_dwordx4 v5, s[16:19], s48 offen lds
  s_add_u32 m0, s54, 34816
  s_add_u32 s48, s46, 18432
  buffer_load_dwordx4 v4, s[16:19], s48 offen lds
  s_add_u32 m0, s54, 35840
  s_add_u32 s48, s46, 27648
  buffer_load_dwordx4 v5, s[16:19], s48 offen lds
  s_mul_i32 s47, s53, 221184
  s_add_u32 s47, s47, s52
  s_add_u32 m0, s55, 71680
  s_nop 0
  buffer_load_dwordx4 v6, s[20:23], s47 offen lds
  s_add_u32 m0, s55, 75776
  s_nop 0
  buffer_load_dwordx4 v7, s[20:23], s47 offen lds
  s_mov_b32 m0, s96
  s_nop 0
  buffer_load_dwordx4 v8, s[20:23], s47 offen lds
  s_add_u32 s53, s53, 1
  s_cmp_eq_u32 s53, 9
  s_cselect_b32 s53, 0, s53
  s_waitcnt lgkmcnt(0)
  s_add_u32 s41, s42, 1
  s_mul_i32 s41, s41, 0x9E3779B1
  s_waitcnt vmcnt(7)
  s_barrier
  s_lshl_b32 s46, s53, 7
  s_add_u32 s46, s46, s51
  s_add_u32 m0, s54, 0
  s_nop 0
  buffer_load_dwordx4 v4, s[16:19], s46 offen lds
  s_add_u32 m0, s54, 1024
  s_add_u32 s48, s46, 9216
  buffer_load_dwordx4 v5, s[16:19], s48 offen lds
  s_add_u32 m0, s54, 2048
  s_add_u32 s48, s46, 18432
  buffer_load_dwordx4 v4, s[16:19], s48 offen lds
  s_add_u32 m0, s54, 3072
  s_add_u32 s48, s46, 27648
  buffer_load_dwordx4 v5, s[16:19], s48 offen lds
  s_mul_i32 s47, s53, 221184
  s_add_u32 s47, s47, s52
  s_add_u32 m0, s55, 49152
  s_nop 0
  buffer_load_dwordx4 v6, s[20:23], s47 offen lds
  s_add_u32 m0, s55, 53248
  s_nop 0
  buffer_load_dwordx4 v7, s[20:23], s47 offen lds
  s_mov_b32 m0, s94
  s_nop 0
  buffer_load_dwordx4 v8, s[20:23], s47 offen lds
  s_add_u32 s53, s53, 1
  s_cmp_eq_u32 s53, 9
  s_cselect_b32 s53, 0, s53
  s_waitcnt vmcnt(7)
  s_barrier
  s_lshl_b32 s46, s53, 7
  s_add_u32 s46, s46, s51
  s_add_u32 m0, s54, 16384
  s_nop 0
  buffer_load_dwordx4 v4, s[16:19], s46 offen lds
  s_add_u32 m0, s54, 17408
  s_add_u32 s48, s46, 9216
  buffer_load_dwordx4 v5, s[16:19], s48 offen lds
  s_add_u32 m0, s54, 18432
  s_add_u32 s48, s46, 18432
  buffer_load_dwordx4 v4, s[16:19], s48 offen lds
  s_add_u32 m0, s54, 19456
  s_add_u32 s48, s46, 27648
  buffer_load_dwordx4 v5, s[16:19], s48 offen lds
  s_mul_i32 s47, s53, 221184
  s_add_u32 s47, s47, s52
  s_add_u32 m0, s55, 60416
  s_nop 0
  buffer_load_dwordx4 v6, s[20:23], s47 offen lds
  s_add_u32 m0, s55, 64512
  s_nop 0
  buffer_load_dwordx4 v7, s[20:23], s47 offen lds
  s_mov_b32 m0, s95
  s_nop 0
  buffer_load_dwordx4 v8, s[20:23], s47 offen lds
  s_add_u32 s53, s53, 1
  s_cmp_eq_u32 s53, 9
  s_cselect_b32 s53, 0, s53
  s_waitcnt vmcnt(7)
  s_barrier
  s_lshl_b32 s46, s53, 7
  s_add_u32 s46, s46, s51
  s_add_u32 m0, s54, 32768
  s_nop 0
  buffer_load_dwordx4 v4, s[16:19], s46 offen lds
  s_add_u32 m0, s54, 33792
  s_add_u32 s48, s46, 9216
  buffer_load_dwordx4 v5, s[16:19], s48 offen lds
  s_add_u32 m0, s54, 34816
  s_add_u32 s48, s46, 18432
  buffer_load_dwordx4 v4, s[16:19], s48 offen lds
  s_add_u32 m0, s54, 35840
  s_add_u32 s48, s46, 27648
  buffer_load_dwordx4 v5, s[16:19], s48 offen lds
  s_mul_i32 s47, s53, 221184
  s_add_u32 s47, s47, s52
  s_add_u32 m0, s55, 71680
  s_nop 0
  buffer_load_dwordx4 v6, s[20:23], s47 offen lds
  s_add_u32 m0, s55, 75776
  s_nop 0
  buffer_load_dwordx4 v7, s[20:23], s47 offen lds
  s_mov_b32 m0, s96
  s_nop 0
  buffer_load_dwordx4 v8, s[20:23], s47 offen lds
  s_add_u32 s53, s53, 1
  s_cmp_eq_u32 s53, 9
  s_cselect_b32 s53, 0, s53
  s_waitcnt vmcnt(7)
  s_barrier
  s_waitcnt vmcnt(0)
  s_barrier
  s_mul_i32 s46, s38, 72
  s_sub_u32 s46, s46, s44
  s_and_b32 s49, s36, 3
  s_mul_i32 s47, s49, 442368
  s_add_u32 s47, s47, s46
  s_mul_i32 s48, s49, 11264
  s_add_u32 s49, s49, 1
  s_and_b32 s49, s49, 3
  s_add_u32 s48, s48, s55
  s_add_u32 m0, s48, 113152
  s_nop 0
  buffer_load_dwordx4 v9, s[20:23], s47 offen lds
  s_add_u32 m0, s48, 117248
  s_nop 0
  buffer_load_dwordx4 v10, s[20:23], s47 offen lds
  s_add_u32 s50, s48, 121344
  s_cmp_eq_u32 s45, 3
  s_cselect_b32 m0, 108544, s50
  s_nop 0
  buffer_load_dwordx4 v11, s[20:23], s47 offen lds
  s_mul_i32 s47, s49, 442368
  s_add_u32 s47, s47, s46
  s_mul_i32 s48, s49, 11264
  s_add_u32 s49, s49, 1
  s_and_b32 s49, s49, 3
  s_add_u32 s48, s48, s55
  s_add_u32 m0, s48, 113152
  s_nop 0
  buffer_load_dwordx4 v9, s[20:23], s47 offen lds
  s_add_u32 m0, s48, 117248
  s_nop 0
  buffer_load_dwordx4 v10, s[20:23], s47 offen lds
  s_add_u32 s50, s48, 121344
  s_cmp_eq_u32 s45, 3
  s_cselect_b32 m0, 108544, s50
  s_nop 0
  buffer_load_dwordx4 v11, s[20:23], s47 offen lds
  s_mul_i32 s47, s49, 442368
  s_add_u32 s47, s47, s46
  s_mul_i32 s48, s49, 11264
  s_add_u32 s49, s49, 1
  s_and_b32 s49, s49, 3
  s_add_u32 s48, s48, s55
  s_add_u32 m0, s48, 113152
  s_nop 0
  buffer_load_dwordx4 v9, s[20:23], s47 offen lds
  s_add_u32 m0, s48, 117248
  s_nop 0
  buffer_load_dwordx4 v10, s[20:23], s47 offen lds
  s_add_u32 s50, s48, 121344
  s_cmp_eq_u32 s45, 3
  s_cselect_b32 m0, 108544, s50
  s_nop 0
  buffer_load_dwordx4 v11, s[20:23], s47 offen lds
  s_mul_i32 s47, s49, 442368
  s_add_u32 s47, s47, s46
  s_mul_i32 s48, s49, 11264
  s_add_u32 s49, s49, 1
  s_and_b32 s49, s49, 3
  s_add_u32 s48, s48, s55
  s_add_u32 m0, s48, 113152
  s_nop 0
  buffer_load_dwordx4 v9, s[20:23], s47 offen lds
  s_add_u32 m0, s48, 117248
  s_nop 0
  buffer_load_dwordx4 v10, s[20:23], s47 offen lds
  s_add_u32 s50, s48, 121344
  s_cmp_eq_u32 s45, 3
  s_cselect_b32 m0, 108544, s50
  s_nop 0
  buffer_load_dwordx4 v11, s[20:23], s47 offen lds
  s_add_u32 s47, s46, 1769472
  s_mov_b32 s48, 45056
  s_add_u32 s48, s48, s55
  s_add_u32 m0, s48, 113152
  s_nop 0
  buffer_load_dwordx4 v9, s[20:23], s47 offen lds
  s_add_u32 m0, s48, 117248
  s_nop 0
  buffer_load_dwordx4 v10, s[20:23], s47 offen lds
  v_mov_b32 v12, -1
  v_mov_b32 v13, -1
  v_mov_b32 v14, -1
  v_mov_b32 v15, -1
  v_lshlrev_b32 v16, 4, v1
  v_lshlrev_b32 v17, 3, v1
  s_lshl_b32 s46, s36, 3
  s_lshl_b32 s47, s45, 1
  s_add_u32 s46, s46, s47
  s_lshl_b32 s46, s46, 14
  s_lshl_b32 s47, s38, 10
  s_add_u32 s46, s46, s47
  s_add_u32 s46, s46, 1048576
  s_add_u32 s47, s46, 16384
  s_lshl_b32 s48, s36, 4
  s_add_u32 s48, s48, s38
  s_lshl_b32 s48, s48, 10
  s_lshl_b32 s49, s45, 8
  s_add_u32 s48, s48, s49
  s_add_u32 s48, s48, 3145728
  buffer_store_dwordx4 v[12:15], v16, s[32:35], s46 offen sc1
  buffer_store_dwordx4 v[12:15], v16, s[32:35], s47 offen sc1
  s_mov_b32 exec_hi, 0
  buffer_store_dwordx2 v[12:13], v17, s[32:35], s48 offen sc1
  s_mov_b32 exec_hi, -1
  s_waitcnt vmcnt(3)
  v_mov_b32 v12, 107752
  v_mov_b32 v13, 1
  s_mov_b64 exec, 1
  ds_add_u32 v12, v13
  s_mov_b64 exec, -1
  s_waitcnt vmcnt(0)
  v_mov_b32 v12, 107772
  v_mov_b32 v13, 1
  s_mov_b64 exec, 1
  ds_add_u32 v12, v13
  s_mov_b64 exec, -1
  s_cmp_eq_u32 s45, 3
  s_cbranch_scc1 L_poll3
  s_lshl_b32 s46, s38, 4
  s_mul_i32 s46, s46, 3072
  s_add_u32 s84, s46, 65536
  s_add_u32 s85, s84, 3072
  s_add_u32 s86, s84, 6144
  s_add_u32 s87, s84, 9216
  s_add_u32 s46, s36, 0
  s_and_b32 s46, s46, 3
  s_mul_i32 s46, s46, 12288
  v_add_u32 v56, s46, v28
  s_add_u32 s46, s36, 1
  s_and_b32 s46, s46, 3
  s_mul_i32 s46, s46, 12288
  v_add_u32 v57, s46, v28
  s_add_u32 s46, s36, 2
  s_and_b32 s46, s46, 3
  s_mul_i32 s46, s46, 12288
  v_add_u32 v58, s46, v28
  s_add_u32 s46, s36, 3
  s_and_b32 s46, s46, 3
  s_mul_i32 s46, s46, 12288
  v_add_u32 v59, s46, v28
  v_mov_b32 v12, 107756
  s_mov_b32 s66, 0
L_whint_1:
  ds_read_b32 v13, v12
  s_waitcnt lgkmcnt(0)
  v_readfirstlane_b32 s12, v13
  s_add_u32 s66, s66, 1
  s_cmp_gt_u32 s66, 1048576
  s_cbranch_scc1 L_whintd_2
  s_cmp_ge_u32 s12, 1
  s_cbranch_scc1 L_whintd_2

  s_branch L_whint_1
L_whintd_2:
  s_mov_b32 s48, 0
  v_cmp_gt_u32 vcc, 189, v24
  s_and_saveexec_b64 s[68:69], vcc
  buffer_load_dwordx4 v[64:67], v56, s[32:35], s84 offen
  buffer_load_dwordx4 v[68:71], v56, s[32:35], s85 offen
  buffer_load_dwordx4 v[72:75], v56, s[32:35], s86 offen
  buffer_load_dwordx4 v[76:79], v56, s[32:35], s87 offen
  buffer_load_dwordx4 v[80:83], v57, s[32:35], s84 offen
  buffer_load_dwordx4 v[84:87], v57, s[32:35], s85 offen
  buffer_load_dwordx4 v[88:91], v57, s[32:35], s86 offen
  buffer_load_dwordx4 v[92:95], v57, s[32:35], s87 offen
  buffer_load_dwordx4 v[96:99], v58, s[32:35], s84 offen
  buffer_load_dwordx4 v[100:103], v58, s[32:35], s85 offen
  buffer_load_dwordx4 v[104:107], v58, s[32:35], s86 offen
  buffer_load_dwordx4 v[108:111], v58, s[32:35], s87 offen
  buffer_load_dwordx4 v[112:115], v59, s[32:35], s84 offen
  buffer_load_dwordx4 v[116:119], v59, s[32:35], s85 offen
  buffer_load_dwordx4 v[120:123], v59, s[32:35], s86 offen
  buffer_load_dwordx4 v[124:127], v59, s[32:35], s87 offen
  s_mov_b64 exec, s[68:69]
  v_mov_b32 v12, 107760
  v_mov_b32 v13, 1
  s_mov_b64 exec, 1
  ds_add_u32 v12, v13
  s_mov_b64 exec, -1
  v_cmp_gt_u32 vcc, 189, v24
  s_nop 3
  s_and_saveexec_b64 s[68:69], vcc
  s_waitcnt vmcnt(15)
  v_max3_u32 v30, v64, v65, v66
  v_max_u32 v30, v30, v67
  s_waitcnt vmcnt(14)
  v_max3_u32 v30, v30, v68, v69
  v_max3_u32 v30, v30, v70, v71
  v_pk_add_f32 v[64:65], v[64:65], v[68:69]
  v_pk_add_f32 v[66:67], v[66:67], v[70:71]
  s_waitcnt vmcnt(13)
  v_max3_u32 v30, v30, v72, v73
  v_max3_u32 v30, v30, v74, v75
  s_waitcnt vmcnt(12)
  v_max3_u32 v30, v30, v76, v77
  v_max3_u32 v30, v30, v78, v79
  v_pk_add_f32 v[72:73], v[72:73], v[76:77]
  v_pk_add_f32 v[74:75], v[74:75], v[78:79]
  v_pk_add_f32 v[64:65], v[64:65], v[72:73]
  v_pk_add_f32 v[66:67], v[66:67], v[74:75]
  s_waitcnt vmcnt(11)
  v_max3_u32 v30, v30, v80, v81
  v_max3_u32 v30, v30, v82, v83
  s_waitcnt vmcnt(10)
  v_max3_u32 v30, v30, v84, v85
  v_max3_u32 v30, v30, v86, v87
  v_pk_add_f32 v[80:81], v[80:81], v[84:85]
  v_pk_add_f32 v[82:83], v[82:83], v[86:87]
  s_waitcnt vmcnt(9)
  v_max3_u32 v30, v30, v88, v89
  v_max3_u32 v30, v30, v90, v91
  s_waitcnt vmcnt(8)
  v_max3_u32 v30, v30, v92, v93
  v_max3_u32 v30, v30, v94, v95
  v_pk_add_f32 v[88:89], v[88:89], v[92:93]
  v_pk_add_f32 v[90:91], v[90:91], v[94:95]
  v_pk_add_f32 v[80:81], v[80:81], v[88:89]
  v_pk_add_f32 v[82:83], v[82:83], v[90:91]
  s_waitcnt vmcnt(7)
  v_max3_u32 v30, v30, v96, v97
  v_max3_u32 v30, v30, v98, v99
  s_waitcnt vmcnt(6)
  v_max3_u32 v30, v30, v100, v101
  v_max3_u32 v30, v30, v102, v103
  v_pk_add_f32 v[96:97], v[96:97], v[100:101]
  v_pk_add_f32 v[98:99], v[98:99], v[102:103]
  s_waitcnt vmcnt(5)
  v_max3_u32 v30, v30, v104, v105
  v_max3_u32 v30, v30, v106, v107
  s_waitcnt vmcnt(4)
  v_max3_u32 v30, v30, v108, v109
  v_max3_u32 v30, v30, v110, v111
  v_pk_add_f32 v[104:105], v[104:105], v[108:109]
  v_pk_add_f32 v[106:107], v[106:107], v[110:111]
  v_pk_add_f32 v[96:97], v[96:97], v[104:105]
  v_pk_add_f32 v[98:99], v[98:99], v[106:107]
  v_pk_add_f32 v[64:65], v[64:65], v[96:97]
  v_pk_add_f32 v[66:67], v[66:67], v[98:99]
  s_waitcnt vmcnt(3)
  v_max3_u32 v30, v30, v112, v113
  v_max3_u32 v30, v30, v114, v115
  s_waitcnt vmcnt(2)
  v_max3_u32 v30, v30, v116, v117
  v_max3_u32 v30, v30, v118, v119
  v_pk_add_f32 v[112:113], v[112:113], v[116:117]
  v_pk_add_f32 v[114:115], v[114:115], v[118:119]
  s_waitcnt vmcnt(1)
  v_max3_u32 v30, v30, v120, v121
  v_max3_u32 v30, v30, v122, v123
  s_waitcnt vmcnt(0)
  v_max3_u32 v30, v30, v124, v125
  v_max3_u32 v30, v30, v126, v127
  v_pk_add_f32 v[120:121], v[120:121], v[124:125]
  v_pk_add_f32 v[122:123], v[122:123], v[126:127]
  v_pk_add_f32 v[112:113], v[112:113], v[120:121]
  v_pk_add_f32 v[114:115], v[114:115], v[122:123]
  v_cmp_eq_u32 vcc, -1, v30
  s_cbranch_vccz L_ppd_4
L_pp_3:
  buffer_load_dwordx4 v[64:67], v56, s[32:35], s84 offen sc1
  buffer_load_dwordx4 v[68:71], v56, s[32:35], s85 offen sc1
  buffer_load_dwordx4 v[72:75], v56, s[32:35], s86 offen sc1
  buffer_load_dwordx4 v[76:79], v56, s[32:35], s87 offen sc1
  buffer_load_dwordx4 v[80:83], v57, s[32:35], s84 offen sc1
  buffer_load_dwordx4 v[84:87], v57, s[32:35], s85 offen sc1
  buffer_load_dwordx4 v[88:91], v57, s[32:35], s86 offen sc1
  buffer_load_dwordx4 v[92:95], v57, s[32:35], s87 offen sc1
  buffer_load_dwordx4 v[96:99], v58, s[32:35], s84 offen sc1
  buffer_load_dwordx4 v[100:103], v58, s[32:35], s85 offen sc1
  buffer_load_dwordx4 v[104:107], v58, s[32:35], s86 offen sc1
  buffer_load_dwordx4 v[108:111], v58, s[32:35], s87 offen sc1
  buffer_load_dwordx4 v[112:115], v59, s[32:35], s84 offen sc1
  buffer_load_dwordx4 v[116:119], v59, s[32:35], s85 offen sc1
  buffer_load_dwordx4 v[120:123], v59, s[32:35], s86 offen sc1
  buffer_load_dwordx4 v[124:127], v59, s[32:35], s87 offen sc1
  s_waitcnt vmcnt(15)
  v_max3_u32 v30, v64, v65, v66
  v_max_u32 v30, v30, v67
  s_waitcnt vmcnt(14)
  v_max3_u32 v30, v30, v68, v69
  v_max3_u32 v30, v30, v70, v71
  v_pk_add_f32 v[64:65], v[64:65], v[68:69]
  v_pk_add_f32 v[66:67], v[66:67], v[70:71]
  s_waitcnt vmcnt(13)
  v_max3_u32 v30, v30, v72, v73
  v_max3_u32 v30, v30, v74, v75
  s_waitcnt vmcnt(12)
  v_max3_u32 v30, v30, v76, v77
  v_max3_u32 v30, v30, v78, v79
  v_pk_add_f32 v[72:73], v[72:73], v[76:77]
  v_pk_add_f32 v[74:75], v[74:75], v[78:79]
  v_pk_add_f32 v[64:65], v[64:65], v[72:73]
  v_pk_add_f32 v[66:67], v[66:67], v[74:75]
  s_waitcnt vmcnt(11)
  v_max3_u32 v30, v30, v80, v81
  v_max3_u32 v30, v30, v82, v83
  s_waitcnt vmcnt(10)
  v_max3_u32 v30, v30, v84, v85
  v_max3_u32 v30, v30, v86, v87
  v_pk_add_f32 v[80:81], v[80:81], v[84:85]
  v_pk_add_f32 v[82:83], v[82:83], v[86:87]
  s_waitcnt vmcnt(9)
  v_max3_u32 v30, v30, v88, v89
  v_max3_u32 v30, v30, v90, v91
  s_waitcnt vmcnt(8)
  v_max3_u32 v30, v30, v92, v93
  v_max3_u32 v30, v30, v94, v95
  v_pk_add_f32 v[88:89], v[88:89], v[92:93]
  v_pk_add_f32 v[90:91], v[90:91], v[94:95]
  v_pk_add_f32 v[80:81], v[80:81], v[88:89]
  v_pk_add_f32 v[82:83], v[82:83], v[90:91]
  s_waitcnt vmcnt(7)
  v_max3_u32 v30, v30, v96, v97
  v_max3_u32 v30, v30, v98, v99
  s_waitcnt vmcnt(6)
  v_max3_u32 v30, v30, v100, v101
  v_max3_u32 v30, v30, v102, v103
  v_pk_add_f32 v[96:97], v[96:97], v[100:101]
  v_pk_add_f32 v[98:99], v[98:99], v[102:103]
  s_waitcnt vmcnt(5)
  v_max3_u32 v30, v30, v104, v105
  v_max3_u32 v30, v30, v106, v107
  s_waitcnt vmcnt(4)
  v_max3_u32 v30, v30, v108, v109
  v_max3_u32 v30, v30, v110, v111
  v_pk_add_f32 v[104:105], v[104:105], v[108:109]
  v_pk_add_f32 v[106:107], v[106:107], v[110:111]
  v_pk_add_f32 v[96:97], v[96:97], v[104:105]
  v_pk_add_f32 v[98:99], v[98:99], v[106:107]
  v_pk_add_f32 v[64:65], v[64:65], v[96:97]
  v_pk_add_f32 v[66:67], v[66:67], v[98:99]
  s_waitcnt vmcnt(3)
  v_max3_u32 v30, v30, v112, v113
  v_max3_u32 v30, v30, v114, v115
  s_waitcnt vmcnt(2)
  v_max3_u32 v30, v30, v116, v117
  v_max3_u32 v30, v30, v118, v119
  v_pk_add_f32 v[112:113], v[112:113], v[116:117]
  v_pk_add_f32 v[114:115], v[114:115], v[118:119]
  s_waitcnt vmcnt(1)
  v_max3_u32 v30, v30, v120, v121
  v_max3_u32 v30, v30, v122, v123
  s_waitcnt vmcnt(0)
  v_max3_u32 v30, v30, v124, v125
  v_max3_u32 v30, v30, v126, v127
  v_pk_add_f32 v[120:121], v[120:121], v[124:125]
  v_pk_add_f32 v[122:123], v[122:123], v[126:127]
  v_pk_add_f32 v[112:113], v[112:113], v[120:121]
  v_pk_add_f32 v[114:115], v[114:115], v[122:123]
  v_cmp_eq_u32 vcc, -1, v30
  s_cbranch_vccz L_ppd_4
  s_add_u32 s48, s48, 1
  s_cmp_gt_u32 s48, 1048576
  s_cbranch_scc0 L_pp_3
L_ppd_4:
  v_pk_add_f32 v[80:81], v[80:81], v[112:113]
  v_pk_add_f32 v[82:83], v[82:83], v[114:115]
  v_pk_add_f32 v[64:65], v[64:65], v[80:81]
  v_pk_add_f32 v[66:67], v[66:67], v[82:83]
  v_cvt_pk_bf16_f32 v30, v64, v65
  v_cvt_pk_bf16_f32 v31, v66, v67
  ds_write_b32 v25, v30
  ds_write_b32 v26, v31
  s_mov_b64 exec, s[68:69]
  v_mov_b32 v12, 107764
  v_mov_b32 v13, 1
  s_mov_b64 exec, 1
  ds_add_u32 v12, v13
  s_mov_b64 exec, -1
  s_branch L_bt
L_poll3:
  s_lshl_b32 s46, s38, 12
  s_add_u32 s57, s46, 3407872
  v_min_u32 v48, 47, v1
  v_lshlrev_b32 v48, 6, v48
  s_lshr_b32 s46, s37, 1
  s_mul_i32 s46, s46, 144
  s_and_b32 s48, s36, 3
  s_lshl_b32 s48, s48, 1
  s_and_b32 s49, s37, 1
  s_add_u32 s48, s48, s49
  s_mul_i32 s48, s48, 11
  s_lshr_b32 s48, s48, 3
  s_add_u32 s50, s48, 0
  s_cmp_ge_u32 s48, 6
  s_cselect_b32 s49, 4, 0
  s_add_u32 s50, s50, s49
  s_cmp_ge_u32 s48, 10
  s_cselect_b32 s49, 3, 0
  s_add_u32 s50, s50, s49
  s_mov_b32 s48, 11
L_woloop_5:
  s_mul_i32 s49, s50, 36864
  s_mul_i32 s47, s50, 5120
  s_add_u32 s49, s49, s46
  s_add_u32 m0, s47, 0
  s_nop 0
  buffer_load_dwordx4 v52, s[24:27], s49 offen lds
  s_add_u32 m0, s47, 1024
  s_nop 0
  buffer_load_dwordx4 v53, s[24:27], s49 offen lds
  s_add_u32 m0, s47, 2048
  s_nop 0
  buffer_load_dwordx4 v54, s[24:27], s49 offen lds
  s_add_u32 m0, s47, 3072
  s_nop 0
  buffer_load_dwordx4 v55, s[24:27], s49 offen lds
  s_add_u32 m0, s47, 4096
  s_nop 0
  buffer_load_dwordx4 v56, s[24:27], s49 offen lds
  s_add_u32 s50, s50, 1
  s_cmp_eq_u32 s50, 6
  s_cselect_b32 s50, 10, s50
  s_cmp_eq_u32 s50, 14
  s_cselect_b32 s50, 17, s50
  s_cmp_eq_u32 s50, 18
  s_cselect_b32 s50, 0, s50
  s_sub_u32 s48, s48, 1
  s_cmp_lg_u32 s48, 0
  s_cbranch_scc1 L_woloop_5
  s_mov_b32 s66, 0
L_ph_6:
  buffer_load_dword v49, v48, s[32:35], s57 offen sc1
  s_waitcnt vmcnt(0)
  v_cmp_ne_u32 vcc, s41, v49
  s_cbranch_vccz L_phd_7
  s_sleep 2
  s_add_u32 s66, s66, 1
  s_cmp_gt_u32 s66, 1048576
  s_cbranch_scc0 L_ph_6
L_phd_7:
  v_mov_b32 v12, 107756
  v_mov_b32 v13, 1
  s_mov_b64 exec, 1
  ds_add_u32 v12, v13
  s_mov_b64 exec, -1
  v_mov_b32 v12, 107748
  s_mov_b32 s66, 0
L_wcnt_8:
  ds_read_b32 v13, v12
  s_waitcnt lgkmcnt(0)
  v_readfirstlane_b32 s12, v13
  s_add_u32 s66, s66, 1
  s_cmp_gt_u32 s66, 1048576
  s_cbranch_scc1 L_wcntd_9
  s_cmp_ge_u32 s12, 4
  s_cbranch_scc1 L_wcntd_9

  s_branch L_wcnt_8
L_wcntd_9:
  v_mov_b32 v12, 107760
  s_mov_b32 s66, 0
L_wgi_10:
  ds_read_b32 v13, v12
  s_waitcnt lgkmcnt(0)
  v_readfirstlane_b32 s12, v13
  s_add_u32 s66, s66, 1
  s_cmp_gt_u32 s66, 1048576
  s_cbranch_scc1 L_wgid_11
  s_cmp_ge_u32 s12, 3
  s_cbranch_scc1 L_wgid_11

  s_branch L_wgi_10
L_wgid_11:
  s_lshr_b32 s46, s37, 1
  s_mul_i32 s46, s46, 144
  s_and_b32 s48, s36, 3
  s_lshl_b32 s48, s48, 1
  s_and_b32 s49, s37, 1
  s_add_u32 s48, s48, s49
  s_mul_i32 s48, s48, 7
  s_lshr_b32 s48, s48, 3
  s_add_u32 s50, s48, 6
  s_cmp_ge_u32 s48, 4
  s_cselect_b32 s49, 4, 0
  s_add_u32 s50, s50, s49
  s_mov_b32 s48, 7
L_woloop_12:
  s_mul_i32 s49, s50, 36864
  s_mul_i32 s47, s50, 5120
  s_add_u32 s49, s49, s46
  s_add_u32 m0, s47, 0
  s_nop 0
  buffer_load_dwordx4 v52, s[24:27], s49 offen lds
  s_add_u32 m0, s47, 1024
  s_nop 0
  buffer_load_dwordx4 v53, s[24:27], s49 offen lds
  s_add_u32 m0, s47, 2048
  s_nop 0
  buffer_load_dwordx4 v54, s[24:27], s49 offen lds
  s_add_u32 m0, s47, 3072
  s_nop 0
  buffer_load_dwordx4 v55, s[24:27], s49 offen lds
  s_add_u32 m0, s47, 4096
  s_nop 0
  buffer_load_dwordx4 v56, s[24:27], s49 offen lds
  s_add_u32 s50, s50, 1
  s_cmp_eq_u32 s50, 10
  s_cselect_b32 s50, 14, s50
  s_cmp_eq_u32 s50, 17
  s_cselect_b32 s50, 6, s50
  s_sub_u32 s48, s48, 1
  s_cmp_lg_u32 s48, 0
  s_cbranch_scc1 L_woloop_12
  s_waitcnt vmcnt(0)
  v_mov_b32 v12, 107768
  v_mov_b32 v13, 1
  s_mov_b64 exec, 1
  ds_add_u32 v12, v13
  s_mov_b64 exec, -1
L_bt:
  s_lshl_b32 s46, s36, 3
  s_and_b32 s47, s37, 1
  s_lshl_b32 s47, s47, 2
  s_add_u32 s47, s47, s45
  s_add_u32 s56, s46, s47
  s_lshr_b32 s48, s47, 1
  s_lshl_b32 s46, s36, 2
  s_add_u32 s46, s46, s48
  s_lshl_b32 s46, s46, 10
  s_add_u32 s57, s46, 3538944
  s_lshl_b32 s46, s36, 14
  s_lshl_b32 s47, s47, 7
  s_add_u32 s46, s46, s47
  s_add_u32 s61, s46, 3145728
  v_and_b32 v2, 15, v1
  v_lshrrev_b32 v3, 4, v1
  v_lshrrev_b32 v7, 2, v2
  v_and_b32 v5, 3, v1
  v_lshlrev_b32 v5, 3, v5
  v_lshlrev_b32 v10, 2, v3
  v_add_u32 v10, v10, v7
  v_mul_u32_u24 v10, 160, v10
  v_add_u32 v10, v10, v5
  v_add_u32 v11, 46080, v10
  v_mul_u32_u24 v12, 72, v3
  v_add_u32 v12, v12, v7
  v_add_u32 v12, 32, v12
  v_mul_u32_u24 v12, 160, v12
  v_add_u32 v12, v12, v5
  v_lshlrev_b32 v15, 6, v2
  v_lshlrev_b32 v13, 11, v3
  v_lshlrev_b32 v7, 3, v2
  v_add_u32 v13, v13, v7
  v_mul_u32_u24 v9, 1152, v2
  v_lshlrev_b32 v7, 3, v3
  v_add_u32 v9, v9, v7
  v_lshlrev_b32 v8, 4, v1
  s_lshl_b32 s46, s56, 14
  s_add_u32 s46, s46, 1048576
  s_mov_b32 s48, 0
  v_mov_b32 v6, 107768
  s_mov_b32 s66, 0
L_wwo1_15:
  ds_read_b32 v7, v6
  s_waitcnt lgkmcnt(0)
  v_readfirstlane_b32 s12, v7
  s_add_u32 s66, s66, 1
  s_cmp_gt_u32 s66, 1048576
  s_cbranch_scc1 L_wwo1d_16
  s_cmp_ge_u32 s12, 1
  s_cbranch_scc1 L_wwo1d_16

  s_branch L_wwo1_15
L_wwo1d_16:
  ds_read_b64_tr_b16 v[16:17], v11 offset:5760
  ds_read_b64_tr_b16 v[18:19], v11 offset:8320
  ds_read_b64_tr_b16 v[20:21], v11 offset:5792
  ds_read_b64_tr_b16 v[22:23], v11 offset:8352
  ds_read_b64_tr_b16 v[24:25], v11 offset:5824
  ds_read_b64_tr_b16 v[26:27], v11 offset:8384
  ds_read_b64_tr_b16 v[28:29], v11 offset:5856
  ds_read_b64_tr_b16 v[30:31], v11 offset:8416
  ds_read_b64_tr_b16 v[32:33], v11 offset:5888
  ds_read_b64_tr_b16 v[34:35], v11 offset:8448
  ds_read_b64_tr_b16 v[36:37], v11 offset:11520
  ds_read_b64_tr_b16 v[38:39], v11 offset:14080
  ds_read_b64_tr_b16 v[40:41], v11 offset:11552
  ds_read_b64_tr_b16 v[42:43], v11 offset:14112
  ds_read_b64_tr_b16 v[44:45], v11 offset:11584
  ds_read_b64_tr_b16 v[46:47], v11 offset:14144
  ds_read_b64_tr_b16 v[48:49], v11 offset:11616
  ds_read_b64_tr_b16 v[50:51], v11 offset:14176
  ds_read_b64_tr_b16 v[52:53], v11 offset:11648
  ds_read_b64_tr_b16 v[54:55], v11 offset:14208
  ds_read_b64_tr_b16 v[56:57], v11 offset:17280
  ds_read_b64_tr_b16 v[58:59], v11 offset:19840
  ds_read_b64_tr_b16 v[60:61], v11 offset:17312
  ds_read_b64_tr_b16 v[62:63], v11 offset:19872
  ds_read_b64_tr_b16 v[64:65], v11 offset:17344
  ds_read_b64_tr_b16 v[66:67], v11 offset:19904
  ds_read_b64_tr_b16 v[68:69], v11 offset:17376
  ds_read_b64_tr_b16 v[70:71], v11 offset:19936
  ds_read_b64_tr_b16 v[72:73], v11 offset:17408
  ds_read_b64_tr_b16 v[74:75], v11 offset:19968
  ds_read_b64_tr_b16 v[76:77], v11 offset:23040
  ds_read_b64_tr_b16 v[78:79], v11 offset:25600
  ds_read_b64_tr_b16 v[80:81], v11 offset:23072
  ds_read_b64_tr_b16 v[82:83], v11 offset:25632
  ds_read_b64_tr_b16 v[84:85], v11 offset:23104
  ds_read_b64_tr_b16 v[86:87], v11 offset:25664
  ds_read_b64_tr_b16 v[88:89], v11 offset:23136
  ds_read_b64_tr_b16 v[90:91], v11 offset:25696
  ds_read_b64_tr_b16 v[92:93], v11 offset:23168
  ds_read_b64_tr_b16 v[94:95], v11 offset:25728
  ds_read_b64_tr_b16 v[96:97], v11 offset:28800
  ds_read_b64_tr_b16 v[98:99], v11 offset:31360
  ds_read_b64_tr_b16 v[100:101], v11 offset:28832
  ds_read_b64_tr_b16 v[102:103], v11 offset:31392
  ds_read_b64_tr_b16 v[104:105], v11 offset:28864
  ds_read_b64_tr_b16 v[106:107], v11 offset:31424
  ds_read_b64_tr_b16 v[108:109], v11 offset:28896
  ds_read_b64_tr_b16 v[110:111], v11 offset:31456
  ds_read_b64_tr_b16 v[112:113], v11 offset:28928
  ds_read_b64_tr_b16 v[114:115], v11 offset:31488
  ds_read_b64_tr_b16 v[116:117], v11 offset:34560
  ds_read_b64_tr_b16 v[118:119], v11 offset:37120
  ds_read_b64_tr_b16 v[120:121], v11 offset:34592
  ds_read_b64_tr_b16 v[122:123], v11 offset:37152
  ds_read_b64_tr_b16 v[124:125], v11 offset:34624
  ds_read_b64_tr_b16 v[126:127], v11 offset:37184
  ds_read_b64_tr_b16 v[128:129], v11 offset:34656
  ds_read_b64_tr_b16 v[130:131], v11 offset:37216
  ds_read_b64_tr_b16 v[132:133], v11 offset:34688
  ds_read_b64_tr_b16 v[134:135], v11 offset:37248
  ds_read_b64_tr_b16 v[136:137], v11 offset:40320
  ds_read_b64_tr_b16 v[138:139], v11 offset:42880
  ds_read_b64_tr_b16 v[140:141], v11 offset:40352
  ds_read_b64_tr_b16 v[142:143], v11 offset:42912
  ds_read_b64_tr_b16 v[144:145], v11 offset:40384
  ds_read_b64_tr_b16 v[146:147], v11 offset:42944
  ds_read_b64_tr_b16 v[148:149], v11 offset:40416
  ds_read_b64_tr_b16 v[150:151], v11 offset:42976
  ds_read_b64_tr_b16 v[152:153], v11 offset:40448
  ds_read_b64_tr_b16 v[154:155], v11 offset:43008
  ds_read_b64_tr_b16 v[156:157], v12 offset:0
  ds_read_b64_tr_b16 v[158:159], v12 offset:5760
  ds_read_b64_tr_b16 v[160:161], v12 offset:32
  ds_read_b64_tr_b16 v[162:163], v12 offset:5792
  ds_read_b64_tr_b16 v[164:165], v12 offset:64
  ds_read_b64_tr_b16 v[166:167], v12 offset:5824
  ds_read_b64_tr_b16 v[168:169], v12 offset:96
  ds_read_b64_tr_b16 v[170:171], v12 offset:5856
  ds_read_b64_tr_b16 v[172:173], v12 offset:128
  ds_read_b64_tr_b16 v[174:175], v12 offset:5888
  ds_read_b64_tr_b16 v[176:177], v12 offset:46080
  ds_read_b64_tr_b16 v[178:179], v12 offset:51840
  ds_read_b64_tr_b16 v[180:181], v12 offset:46112
  ds_read_b64_tr_b16 v[182:183], v12 offset:51872
  ds_read_b64_tr_b16 v[184:185], v12 offset:46144
  ds_read_b64_tr_b16 v[186:187], v12 offset:51904
  ds_read_b64_tr_b16 v[188:189], v12 offset:46176
  ds_read_b64_tr_b16 v[190:191], v12 offset:51936
  ds_read_b64_tr_b16 v[192:193], v12 offset:46208
  ds_read_b64_tr_b16 v[194:195], v12 offset:51968
  s_barrier
  s_add_u32 s47, s46, 8192
  buffer_load_dwordx4 v[196:199], v8, s[32:35], s47 offen offset:1024
  buffer_load_dwordx4 v[200:203], v8, s[32:35], s47 offen offset:2048
  buffer_load_dwordx4 v[204:207], v8, s[32:35], s47 offen offset:3072
  s_add_u32 s47, s46, 12288
  buffer_load_dwordx4 v[208:211], v8, s[32:35], s47 offen offset:0
  buffer_load_dwordx4 v[212:215], v8, s[32:35], s47 offen offset:1024
  buffer_load_dwordx4 v[216:219], v8, s[32:35], s47 offen offset:2048
  buffer_load_dwordx4 v[220:223], v8, s[32:35], s47 offen offset:3072
  s_add_u32 s47, s61, 0
  buffer_load_dwordx2 v[224:225], v13, s[32:35], s47 offen
  buffer_load_dwordx2 v[226:227], v13, s[32:35], s47 offen offset:1024
  s_add_u32 s47, s61, 8192
  buffer_load_dwordx2 v[228:229], v13, s[32:35], s47 offen
  buffer_load_dwordx2 v[230:231], v13, s[32:35], s47 offen offset:1024
  s_waitcnt vmcnt(10) lgkmcnt(0)
  v_mfma_f32_16x16x32_bf16 v[232:235], v[16:19], v[196:199], 0
  v_mfma_f32_16x16x32_bf16 v[236:239], v[20:23], v[196:199], 0
  v_max3_u32 v5, v196, v197, v198
  v_max_u32 v5, v5, v199
  v_mfma_f32_16x16x32_bf16 v[240:243], v[24:27], v[196:199], 0
  v_mfma_f32_16x16x32_bf16 v[244:247], v[28:31], v[196:199], 0
  v_mfma_f32_16x16x32_bf16 v[248:251], v[32:35], v[196:199], 0
  s_waitcnt vmcnt(9)
  v_mfma_f32_16x16x32_bf16 v[232:235], v[36:39], v[200:203], v[232:235]
  v_mfma_f32_16x16x32_bf16 v[236:239], v[40:43], v[200:203], v[236:239]
  v_max3_u32 v5, v5, v200, v201
  v_max3_u32 v5, v5, v202, v203
  v_mfma_f32_16x16x32_bf16 v[240:243], v[44:47], v[200:203], v[240:243]
  v_mfma_f32_16x16x32_bf16 v[244:247], v[48:51], v[200:203], v[244:247]
  v_mfma_f32_16x16x32_bf16 v[248:251], v[52:55], v[200:203], v[248:251]
  s_waitcnt vmcnt(8)
  v_mfma_f32_16x16x32_bf16 v[232:235], v[56:59], v[204:207], v[232:235]
  v_mfma_f32_16x16x32_bf16 v[236:239], v[60:63], v[204:207], v[236:239]
  v_max3_u32 v5, v5, v204, v205
  v_max3_u32 v5, v5, v206, v207
  v_mfma_f32_16x16x32_bf16 v[240:243], v[64:67], v[204:207], v[240:243]
  v_mfma_f32_16x16x32_bf16 v[244:247], v[68:71], v[204:207], v[244:247]
  v_mfma_f32_16x16x32_bf16 v[248:251], v[72:75], v[204:207], v[248:251]
  s_waitcnt vmcnt(7)
  v_mfma_f32_16x16x32_bf16 v[232:235], v[76:79], v[208:211], v[232:235]
  v_mfma_f32_16x16x32_bf16 v[236:239], v[80:83], v[208:211], v[236:239]
  v_max3_u32 v5, v5, v208, v209
  v_max3_u32 v5, v5, v210, v211
  v_mfma_f32_16x16x32_bf16 v[240:243], v[84:87], v[208:211], v[240:243]
  v_mfma_f32_16x16x32_bf16 v[244:247], v[88:91], v[208:211], v[244:247]
  v_mfma_f32_16x16x32_bf16 v[248:251], v[92:95], v[208:211], v[248:251]
  s_waitcnt vmcnt(6)
  v_mfma_f32_16x16x32_bf16 v[232:235], v[96:99], v[212:215], v[232:235]
  v_mfma_f32_16x16x32_bf16 v[236:239], v[100:103], v[212:215], v[236:239]
  v_max3_u32 v5, v5, v212, v213
  v_max3_u32 v5, v5, v214, v215
  v_mfma_f32_16x16x32_bf16 v[240:243], v[104:107], v[212:215], v[240:243]
  v_mfma_f32_16x16x32_bf16 v[244:247], v[108:111], v[212:215], v[244:247]
  v_mfma_f32_16x16x32_bf16 v[248:251], v[112:115], v[212:215], v[248:251]
  s_waitcnt vmcnt(5)
  v_mfma_f32_16x16x32_bf16 v[232:235], v[116:119], v[216:219], v[232:235]
  v_mfma_f32_16x16x32_bf16 v[236:239], v[120:123], v[216:219], v[236:239]
  v_max3_u32 v5, v5, v216, v217
  v_max3_u32 v5, v5, v218, v219
  v_mfma_f32_16x16x32_bf16 v[240:243], v[124:127], v[216:219], v[240:243]
  v_mfma_f32_16x16x32_bf16 v[244:247], v[128:131], v[216:219], v[244:247]
  v_mfma_f32_16x16x32_bf16 v[248:251], v[132:135], v[216:219], v[248:251]
  s_waitcnt vmcnt(4)
  v_mfma_f32_16x16x32_bf16 v[232:235], v[136:139], v[220:223], v[232:235]
  v_mfma_f32_16x16x32_bf16 v[236:239], v[140:143], v[220:223], v[236:239]
  v_max3_u32 v5, v5, v220, v221
  v_max3_u32 v5, v5, v222, v223
  v_mfma_f32_16x16x32_bf16 v[240:243], v[144:147], v[220:223], v[240:243]
  v_mfma_f32_16x16x32_bf16 v[244:247], v[148:151], v[220:223], v[244:247]
  v_mfma_f32_16x16x32_bf16 v[248:251], v[152:155], v[220:223], v[248:251]
  s_waitcnt vmcnt(2)
  v_mfma_f32_16x16x32_bf16 v[232:235], v[156:159], v[224:227], v[232:235]
  v_mfma_f32_16x16x32_bf16 v[236:239], v[160:163], v[224:227], v[236:239]
  v_max3_u32 v5, v5, v224, v225
  v_max3_u32 v5, v5, v226, v227
  v_mfma_f32_16x16x32_bf16 v[240:243], v[164:167], v[224:227], v[240:243]
  v_mfma_f32_16x16x32_bf16 v[244:247], v[168:171], v[224:227], v[244:247]
  v_mfma_f32_16x16x32_bf16 v[248:251], v[172:175], v[224:227], v[248:251]
  s_waitcnt vmcnt(0)
  v_mfma_f32_16x16x32_bf16 v[232:235], v[176:179], v[228:231], v[232:235]
  v_mfma_f32_16x16x32_bf16 v[236:239], v[180:183], v[228:231], v[236:239]
  v_max3_u32 v5, v5, v228, v229
  v_max3_u32 v5, v5, v230, v231
  v_mfma_f32_16x16x32_bf16 v[240:243], v[184:187], v[228:231], v[240:243]
  v_mfma_f32_16x16x32_bf16 v[244:247], v[188:191], v[228:231], v[244:247]
  v_mfma_f32_16x16x32_bf16 v[248:251], v[192:195], v[228:231], v[248:251]
  v_cmp_eq_u32 vcc, -1, v5
  s_cbranch_vccz L_opd_14
L_op_13:
  s_nop 7
  s_add_u32 s48, s48, 1
  s_add_u32 s47, s46, 8192
  buffer_load_dwordx4 v[196:199], v8, s[32:35], s47 offen offset:1024 sc1
  buffer_load_dwordx4 v[200:203], v8, s[32:35], s47 offen offset:2048 sc1
  buffer_load_dwordx4 v[204:207], v8, s[32:35], s47 offen offset:3072 sc1
  s_add_u32 s47, s46, 12288
  buffer_load_dwordx4 v[208:211], v8, s[32:35], s47 offen offset:0 sc1
  buffer_load_dwordx4 v[212:215], v8, s[32:35], s47 offen offset:1024 sc1
  buffer_load_dwordx4 v[216:219], v8, s[32:35], s47 offen offset:2048 sc1
  buffer_load_dwordx4 v[220:223], v8, s[32:35], s47 offen offset:3072 sc1
  s_add_u32 s47, s61, 0
  buffer_load_dwordx2 v[224:225], v13, s[32:35], s47 offen sc1
  buffer_load_dwordx2 v[226:227], v13, s[32:35], s47 offen offset:1024 sc1
  s_add_u32 s47, s61, 8192
  buffer_load_dwordx2 v[228:229], v13, s[32:35], s47 offen sc1
  buffer_load_dwordx2 v[230:231], v13, s[32:35], s47 offen offset:1024 sc1
  s_waitcnt vmcnt(10) lgkmcnt(0)
  v_mfma_f32_16x16x32_bf16 v[232:235], v[16:19], v[196:199], 0
  v_mfma_f32_16x16x32_bf16 v[236:239], v[20:23], v[196:199], 0
  v_max3_u32 v5, v196, v197, v198
  v_max_u32 v5, v5, v199
  v_mfma_f32_16x16x32_bf16 v[240:243], v[24:27], v[196:199], 0
  v_mfma_f32_16x16x32_bf16 v[244:247], v[28:31], v[196:199], 0
  v_mfma_f32_16x16x32_bf16 v[248:251], v[32:35], v[196:199], 0
  s_waitcnt vmcnt(9)
  v_mfma_f32_16x16x32_bf16 v[232:235], v[36:39], v[200:203], v[232:235]
  v_mfma_f32_16x16x32_bf16 v[236:239], v[40:43], v[200:203], v[236:239]
  v_max3_u32 v5, v5, v200, v201
  v_max3_u32 v5, v5, v202, v203
  v_mfma_f32_16x16x32_bf16 v[240:243], v[44:47], v[200:203], v[240:243]
  v_mfma_f32_16x16x32_bf16 v[244:247], v[48:51], v[200:203], v[244:247]
  v_mfma_f32_16x16x32_bf16 v[248:251], v[52:55], v[200:203], v[248:251]
  s_waitcnt vmcnt(8)
  v_mfma_f32_16x16x32_bf16 v[232:235], v[56:59], v[204:207], v[232:235]
  v_mfma_f32_16x16x32_bf16 v[236:239], v[60:63], v[204:207], v[236:239]
  v_max3_u32 v5, v5, v204, v205
  v_max3_u32 v5, v5, v206, v207
  v_mfma_f32_16x16x32_bf16 v[240:243], v[64:67], v[204:207], v[240:243]
  v_mfma_f32_16x16x32_bf16 v[244:247], v[68:71], v[204:207], v[244:247]
  v_mfma_f32_16x16x32_bf16 v[248:251], v[72:75], v[204:207], v[248:251]
  s_waitcnt vmcnt(7)
  v_mfma_f32_16x16x32_bf16 v[232:235], v[76:79], v[208:211], v[232:235]
  v_mfma_f32_16x16x32_bf16 v[236:239], v[80:83], v[208:211], v[236:239]
  v_max3_u32 v5, v5, v208, v209
  v_max3_u32 v5, v5, v210, v211
  v_mfma_f32_16x16x32_bf16 v[240:243], v[84:87], v[208:211], v[240:243]
  v_mfma_f32_16x16x32_bf16 v[244:247], v[88:91], v[208:211], v[244:247]
  v_mfma_f32_16x16x32_bf16 v[248:251], v[92:95], v[208:211], v[248:251]
  s_waitcnt vmcnt(6)
  v_mfma_f32_16x16x32_bf16 v[232:235], v[96:99], v[212:215], v[232:235]
  v_mfma_f32_16x16x32_bf16 v[236:239], v[100:103], v[212:215], v[236:239]
  v_max3_u32 v5, v5, v212, v213
  v_max3_u32 v5, v5, v214, v215
  v_mfma_f32_16x16x32_bf16 v[240:243], v[104:107], v[212:215], v[240:243]
  v_mfma_f32_16x16x32_bf16 v[244:247], v[108:111], v[212:215], v[244:247]
  v_mfma_f32_16x16x32_bf16 v[248:251], v[112:115], v[212:215], v[248:251]
  s_waitcnt vmcnt(5)
  v_mfma_f32_16x16x32_bf16 v[232:235], v[116:119], v[216:219], v[232:235]
  v_mfma_f32_16x16x32_bf16 v[236:239], v[120:123], v[216:219], v[236:239]
  v_max3_u32 v5, v5, v216, v217
  v_max3_u32 v5, v5, v218, v219
  v_mfma_f32_16x16x32_bf16 v[240:243], v[124:127], v[216:219], v[240:243]
  v_mfma_f32_16x16x32_bf16 v[244:247], v[128:131], v[216:219], v[244:247]
  v_mfma_f32_16x16x32_bf16 v[248:251], v[132:135], v[216:219], v[248:251]
  s_waitcnt vmcnt(4)
  v_mfma_f32_16x16x32_bf16 v[232:235], v[136:139], v[220:223], v[232:235]
  v_mfma_f32_16x16x32_bf16 v[236:239], v[140:143], v[220:223], v[236:239]
  v_max3_u32 v5, v5, v220, v221
  v_max3_u32 v5, v5, v222, v223
  v_mfma_f32_16x16x32_bf16 v[240:243], v[144:147], v[220:223], v[240:243]
  v_mfma_f32_16x16x32_bf16 v[244:247], v[148:151], v[220:223], v[244:247]
  v_mfma_f32_16x16x32_bf16 v[248:251], v[152:155], v[220:223], v[248:251]
  s_waitcnt vmcnt(2)
  v_mfma_f32_16x16x32_bf16 v[232:235], v[156:159], v[224:227], v[232:235]
  v_mfma_f32_16x16x32_bf16 v[236:239], v[160:163], v[224:227], v[236:239]
  v_max3_u32 v5, v5, v224, v225
  v_max3_u32 v5, v5, v226, v227
  v_mfma_f32_16x16x32_bf16 v[240:243], v[164:167], v[224:227], v[240:243]
  v_mfma_f32_16x16x32_bf16 v[244:247], v[168:171], v[224:227], v[244:247]
  v_mfma_f32_16x16x32_bf16 v[248:251], v[172:175], v[224:227], v[248:251]
  s_waitcnt vmcnt(0)
  v_mfma_f32_16x16x32_bf16 v[232:235], v[176:179], v[228:231], v[232:235]
  v_mfma_f32_16x16x32_bf16 v[236:239], v[180:183], v[228:231], v[236:239]
  v_max3_u32 v5, v5, v228, v229
  v_max3_u32 v5, v5, v230, v231
  v_mfma_f32_16x16x32_bf16 v[240:243], v[184:187], v[228:231], v[240:243]
  v_mfma_f32_16x16x32_bf16 v[244:247], v[188:191], v[228:231], v[244:247]
  v_mfma_f32_16x16x32_bf16 v[248:251], v[192:195], v[228:231], v[248:251]
  v_cmp_eq_u32 vcc, -1, v5
  s_cbranch_vccz L_opd_14
  s_cmp_gt_u32 s48, 1048576
  s_cbranch_scc0 L_op_13
L_opd_14:
  s_mul_i32 s49, s45, 5120
  s_add_u32 s49, s49, 113152
  v_add_u32 v6, s49, v8
  s_lshl_b32 s49, s45, 2
  s_add_u32 s49, s49, 107788
  s_nop 3
  ds_write_b128 v6, v[232:235] offset:0
  ds_write_b128 v6, v[236:239] offset:1024
  ds_write_b128 v6, v[240:243] offset:2048
  ds_write_b128 v6, v[244:247] offset:3072
  ds_write_b128 v6, v[248:251] offset:4096
  v_mov_b32 v2, s49
  v_mov_b32 v3, 1
  s_mov_b64 exec, 1
  ds_write_b32 v2, v3
  s_mov_b64 exec, -1
  s_waitcnt lgkmcnt(0)
  s_endpgm
L_compute:
  s_sub_u32 s45, s39, 4
  s_mov_b32 s62, 0x3fb8aa3b
  s_mov_b32 s63, 0x3fb8aa3b
  s_mov_b32 s64, 0x358637bd
  s_mov_b32 s65, 0x358637bd
  v_and_b32 v2, 15, v1
  v_lshrrev_b32 v3, 4, v1
  v_lshrrev_b32 v4, 1, v2
  v_xor_b32 v4, v3, v4
  v_lshlrev_b32 v4, 4, v4
  v_lshlrev_b32 v5, 7, v2
  s_lshl_b32 s46, s45, 12
  v_add3_u32 v96, v4, v5, s46
  v_xor_b32 v97, 64, v96
  v_lshrrev_b32 v6, 2, v2
  v_and_b32 v7, 3, v1
  v_mul_u32_u24 v8, 1408, v3
  v_mul_u32_u24 v9, 160, v6
  v_add_u32 v8, v8, v9
  v_lshlrev_b32 v9, 3, v7
  v_add_u32 v10, v8, v9
  s_add_u32 s46, s43, 49152
  v_add_u32 v98, s46, v10
  v_add_u32 v100, 104, v98
  v_add_u32 v11, 72, v98
  v_add_u32 v12, 64, v98
  v_cmp_eq_u32 vcc, 0, v7
  s_add_u32 s46, s44, 113152
  v_add_u32 v109, s46, v10
  v_cndmask_b32 v99, v11, v12, vcc
  s_waitcnt lgkmcnt(0)
  s_load_dword s42, s[14:15], 0
  s_barrier
  ds_read_b128 v[112:115], v96 offset:0
  ds_read_b128 v[116:119], v96 offset:2048
  ds_read_b64_tr_b16 v[56:57], v98 offset:0
  ds_read_b64_tr_b16 v[58:59], v98 offset:640
  ds_read_b64_tr_b16 v[60:61], v98 offset:32
  ds_read_b64_tr_b16 v[62:63], v98 offset:672
  ds_read_b64_tr_b16 v[64:65], v99 offset:0
  ds_read_b64_tr_b16 v[66:67], v99 offset:640
  ds_read_b64_tr_b16 v[68:69], v100 offset:0
  ds_read_b64_tr_b16 v[70:71], v100 offset:640
  ds_read_b64_tr_b16 v[72:73], v100 offset:32
  ds_read_b64_tr_b16 v[74:75], v100 offset:672
  s_waitcnt lgkmcnt(0)
  v_mfma_f32_16x16x32_bf16 v[16:19], v[112:115], v[56:59], 0
  ds_read_b128 v[120:123], v97 offset:0
  ds_read_b128 v[124:127], v97 offset:2048
  v_mfma_f32_16x16x32_bf16 v[36:39], v[116:119], v[56:59], 0
  ds_read_b64_tr_b16 v[76:77], v98 offset:5632
  ds_read_b64_tr_b16 v[78:79], v98 offset:6272
  v_mfma_f32_16x16x32_bf16 v[20:23], v[112:115], v[60:63], 0
  ds_read_b64_tr_b16 v[80:81], v98 offset:5664
  ds_read_b64_tr_b16 v[82:83], v98 offset:6304
  v_mfma_f32_16x16x32_bf16 v[40:43], v[116:119], v[60:63], 0
  ds_read_b64_tr_b16 v[84:85], v99 offset:5632
  ds_read_b64_tr_b16 v[86:87], v99 offset:6272
  v_mfma_f32_16x16x32_bf16 v[24:27], v[112:115], v[64:67], 0
  ds_read_b64_tr_b16 v[88:89], v100 offset:5632
  ds_read_b64_tr_b16 v[90:91], v100 offset:6272
  v_mfma_f32_16x16x32_bf16 v[44:47], v[116:119], v[64:67], 0
  ds_read_b64_tr_b16 v[92:93], v100 offset:5664
  ds_read_b64_tr_b16 v[94:95], v100 offset:6304
  v_mfma_f32_16x16x32_bf16 v[28:31], v[112:115], v[68:71], 0
  v_mfma_f32_16x16x32_bf16 v[48:51], v[116:119], v[68:71], 0
  v_mfma_f32_16x16x32_bf16 v[32:35], v[112:115], v[72:75], 0
  v_mfma_f32_16x16x32_bf16 v[52:55], v[116:119], v[72:75], 0
  s_mul_i32 s46, s45, 3072
  s_add_u32 s46, s46, 92160
  v_mov_b32 v13, 3040
  v_add_u32 v13, s46, v13
  v_lshlrev_b32 v14, 4, v3
  v_add_u32 v14, s46, v14
  v_mul_u32_u24 v15, 80, v2
  v_add_u32 v5, v14, v15
  v_subrev_u32 v6, 320, v5
  v_cmp_le_u32 vcc, 4, v2
  v_cmp_eq_u32 s[48:49], 0, v3
  s_nop 0
  v_cndmask_b32 v101, v13, v6, vcc
  s_and_b64 s[50:51], vcc, s[48:49]
  v_add_u32 v6, 64, v6
  v_cndmask_b32 v104, v13, v6, s[50:51]
  v_add_u32 v6, 960, v5
  v_cmp_gt_u32 vcc, 6, v2
  s_nop 1
  v_cndmask_b32 v102, v13, v6, vcc
  s_and_b64 s[50:51], vcc, s[48:49]
  v_add_u32 v7, 64, v6
  v_cndmask_b32 v8, v13, v7, s[50:51]
  v_cndmask_b32 v105, v6, v8, vcc
  v_add_u32 v7, 64, v6
  s_andn2_b64 s[50:51], s[48:49], vcc
  s_nop 0
  v_cndmask_b32 v107, v13, v7, s[50:51]
  v_add_u32 v6, 2176, v5
  v_add_u32 v7, 2880, v14
  v_cmp_eq_u32 vcc, 8, v2
  v_cmp_gt_u32 s[50:51], 8, v2
  s_nop 0
  v_cndmask_b32 v103, v13, v7, vcc
  v_add_u32 v6, 64, v6
  v_add_u32 v7, 64, v7
  v_cndmask_b32 v8, v13, v6, s[50:51]
  v_cndmask_b32 v106, v8, v7, vcc
  v_add_u32 v6, 64, v6
  v_add_u32 v7, 64, v7
  v_cndmask_b32 v8, v13, v6, s[50:51]
  v_cndmask_b32 v8, v8, v7, vcc
  v_cndmask_b32 v108, v13, v8, s[48:49]
  s_waitcnt lgkmcnt(0)
  s_mov_b32 s28, s10
  s_and_b32 s29, s11, 0xffff
  s_mov_b32 s30, 2359296
  s_mov_b32 s31, 0x00020000
  s_mov_b32 s32, s14
  s_and_b32 s33, s15, 0xffff
  s_mov_b32 s34, 268435456
  s_mov_b32 s35, 0x00020000
  v_mov_b32 v4, -1
  v_mov_b32 v5, -1
  v_mov_b32 v6, -1
  v_mov_b32 v7, -1
  v_lshlrev_b32 v8, 4, v1
  s_lshl_b32 s46, s36, 3
  s_lshl_b32 s47, s45, 1
  s_add_u32 s46, s46, s47
  s_lshl_b32 s46, s46, 14
  s_add_u32 s46, s46, 1048576
  s_lshl_b32 s58, s38, 10
  s_add_u32 s58, s58, s46
  s_lshl_b32 s46, s36, 4
  s_add_u32 s46, s46, s38
  s_lshl_b32 s46, s46, 10
  s_lshl_b32 s47, s45, 8
  s_add_u32 s46, s46, s47
  s_add_u32 s59, s46, 3145728
  s_waitcnt lgkmcnt(0)
  s_add_u32 s41, s42, 1
  s_mul_i32 s41, s41, 0x9E3779B1
  s_waitcnt lgkmcnt(0)
  s_barrier
  v_mfma_f32_16x16x32_bf16 v[16:19], v[120:123], v[76:79], v[16:19]
  ds_read_b128 v[128:131], v96 offset:16384
  ds_read_b128 v[132:135], v96 offset:18432
  v_mfma_f32_16x16x32_bf16 v[36:39], v[124:127], v[76:79], v[36:39]
  ds_read_b64_tr_b16 v[56:57], v98 offset:11264
  ds_read_b64_tr_b16 v[58:59], v98 offset:11904
  v_mfma_f32_16x16x32_bf16 v[20:23], v[120:123], v[80:83], v[20:23]
  ds_read_b64_tr_b16 v[60:61], v98 offset:11296
  ds_read_b64_tr_b16 v[62:63], v98 offset:11936
  v_mfma_f32_16x16x32_bf16 v[40:43], v[124:127], v[80:83], v[40:43]
  ds_read_b64_tr_b16 v[64:65], v99 offset:11264
  ds_read_b64_tr_b16 v[66:67], v99 offset:11904
  v_mfma_f32_16x16x32_bf16 v[24:27], v[120:123], v[84:87], v[24:27]
  ds_read_b64_tr_b16 v[68:69], v100 offset:11264
  ds_read_b64_tr_b16 v[70:71], v100 offset:11904
  v_mfma_f32_16x16x32_bf16 v[44:47], v[124:127], v[84:87], v[44:47]
  ds_read_b64_tr_b16 v[72:73], v100 offset:11296
  ds_read_b64_tr_b16 v[74:75], v100 offset:11936
  v_mfma_f32_16x16x32_bf16 v[28:31], v[120:123], v[88:91], v[28:31]
  v_mfma_f32_16x16x32_bf16 v[48:51], v[124:127], v[88:91], v[48:51]
  v_mfma_f32_16x16x32_bf16 v[32:35], v[120:123], v[92:95], v[32:35]
  v_mfma_f32_16x16x32_bf16 v[52:55], v[124:127], v[92:95], v[52:55]
  s_waitcnt lgkmcnt(0)
  v_mfma_f32_16x16x32_bf16 v[16:19], v[128:131], v[56:59], v[16:19]
  ds_read_b128 v[136:139], v97 offset:16384
  ds_read_b128 v[140:143], v97 offset:18432
  v_mfma_f32_16x16x32_bf16 v[36:39], v[132:135], v[56:59], v[36:39]
  ds_read_b64_tr_b16 v[76:77], v98 offset:16896
  ds_read_b64_tr_b16 v[78:79], v98 offset:17536
  v_mfma_f32_16x16x32_bf16 v[20:23], v[128:131], v[60:63], v[20:23]
  ds_read_b64_tr_b16 v[80:81], v98 offset:16928
  ds_read_b64_tr_b16 v[82:83], v98 offset:17568
  v_mfma_f32_16x16x32_bf16 v[40:43], v[132:135], v[60:63], v[40:43]
  ds_read_b64_tr_b16 v[84:85], v99 offset:16896
  ds_read_b64_tr_b16 v[86:87], v99 offset:17536
  v_mfma_f32_16x16x32_bf16 v[24:27], v[128:131], v[64:67], v[24:27]
  ds_read_b64_tr_b16 v[88:89], v100 offset:16896
  ds_read_b64_tr_b16 v[90:91], v100 offset:17536
  v_mfma_f32_16x16x32_bf16 v[44:47], v[132:135], v[64:67], v[44:47]
  ds_read_b64_tr_b16 v[92:93], v100 offset:16928
  ds_read_b64_tr_b16 v[94:95], v100 offset:17568
  v_mfma_f32_16x16x32_bf16 v[28:31], v[128:131], v[68:71], v[28:31]
  v_mfma_f32_16x16x32_bf16 v[48:51], v[132:135], v[68:71], v[48:51]
  v_mfma_f32_16x16x32_bf16 v[32:35], v[128:131], v[72:75], v[32:35]
  v_mfma_f32_16x16x32_bf16 v[52:55], v[132:135], v[72:75], v[52:55]
  s_waitcnt lgkmcnt(0)
  s_barrier
  v_mfma_f32_16x16x32_bf16 v[16:19], v[136:139], v[76:79], v[16:19]
  ds_read_b128 v[144:147], v96 offset:32768
  ds_read_b128 v[148:151], v96 offset:34816
  v_mfma_f32_16x16x32_bf16 v[36:39], v[140:143], v[76:79], v[36:39]
  ds_read_b64_tr_b16 v[56:57], v98 offset:22528
  ds_read_b64_tr_b16 v[58:59], v98 offset:23168
  v_mfma_f32_16x16x32_bf16 v[20:23], v[136:139], v[80:83], v[20:23]
  ds_read_b64_tr_b16 v[60:61], v98 offset:22560
  ds_read_b64_tr_b16 v[62:63], v98 offset:23200
  v_mfma_f32_16x16x32_bf16 v[40:43], v[140:143], v[80:83], v[40:43]
  ds_read_b64_tr_b16 v[64:65], v99 offset:22528
  ds_read_b64_tr_b16 v[66:67], v99 offset:23168
  v_mfma_f32_16x16x32_bf16 v[24:27], v[136:139], v[84:87], v[24:27]
  ds_read_b64_tr_b16 v[68:69], v100 offset:22528
  ds_read_b64_tr_b16 v[70:71], v100 offset:23168
  v_mfma_f32_16x16x32_bf16 v[44:47], v[140:143], v[84:87], v[44:47]
  ds_read_b64_tr_b16 v[72:73], v100 offset:22560
  ds_read_b64_tr_b16 v[74:75], v100 offset:23200
  v_mfma_f32_16x16x32_bf16 v[28:31], v[136:139], v[88:91], v[28:31]
  v_mfma_f32_16x16x32_bf16 v[48:51], v[140:143], v[88:91], v[48:51]
  v_mfma_f32_16x16x32_bf16 v[32:35], v[136:139], v[92:95], v[32:35]
  v_mfma_f32_16x16x32_bf16 v[52:55], v[140:143], v[92:95], v[52:55]
  s_waitcnt lgkmcnt(0)
  v_mfma_f32_16x16x32_bf16 v[16:19], v[144:147], v[56:59], v[16:19]
  ds_read_b128 v[152:155], v97 offset:32768
  ds_read_b128 v[156:159], v97 offset:34816
  v_mfma_f32_16x16x32_bf16 v[36:39], v[148:151], v[56:59], v[36:39]
  ds_read_b64_tr_b16 v[76:77], v98 offset:28160
  ds_read_b64_tr_b16 v[78:79], v98 offset:28800
  v_mfma_f32_16x16x32_bf16 v[20:23], v[144:147], v[60:63], v[20:23]
  ds_read_b64_tr_b16 v[80:81], v98 offset:28192
  ds_read_b64_tr_b16 v[82:83], v98 offset:28832
  v_mfma_f32_16x16x32_bf16 v[40:43], v[148:151], v[60:63], v[40:43]
  ds_read_b64_tr_b16 v[84:85], v99 offset:28160
  ds_read_b64_tr_b16 v[86:87], v99 offset:28800
  v_mfma_f32_16x16x32_bf16 v[24:27], v[144:147], v[64:67], v[24:27]
  ds_read_b64_tr_b16 v[88:89], v100 offset:28160
  ds_read_b64_tr_b16 v[90:91], v100 offset:28800
  v_mfma_f32_16x16x32_bf16 v[44:47], v[148:151], v[64:67], v[44:47]
  ds_read_b64_tr_b16 v[92:93], v100 offset:28192
  ds_read_b64_tr_b16 v[94:95], v100 offset:28832
  v_mfma_f32_16x16x32_bf16 v[28:31], v[144:147], v[68:71], v[28:31]
  v_mfma_f32_16x16x32_bf16 v[48:51], v[148:151], v[68:71], v[48:51]
  v_mfma_f32_16x16x32_bf16 v[32:35], v[144:147], v[72:75], v[32:35]
  v_mfma_f32_16x16x32_bf16 v[52:55], v[148:151], v[72:75], v[52:55]
  s_lshl_b32 s46, s37, 4
  s_add_u32 s46, s46, s36
  s_mul_i32 s46, s46, 3072
  s_add_u32 s46, s46, 65536
  s_lshl_b32 s47, s45, 10
  s_add_u32 s46, s46, s47
  s_cmp_eq_u32 s45, 3
  s_cbranch_scc1 L_pz_17
  buffer_store_dwordx4 v[4:7], v8, s[32:35], s46 offen sc1

L_pz_17:
  s_waitcnt lgkmcnt(0)
  s_barrier
  v_mfma_f32_16x16x32_bf16 v[16:19], v[152:155], v[76:79], v[16:19]
  ds_read_b128 v[160:163], v96 offset:0
  ds_read_b128 v[164:167], v96 offset:2048
  v_mfma_f32_16x16x32_bf16 v[36:39], v[156:159], v[76:79], v[36:39]
  ds_read_b64_tr_b16 v[56:57], v98 offset:0
  ds_read_b64_tr_b16 v[58:59], v98 offset:640
  v_mfma_f32_16x16x32_bf16 v[20:23], v[152:155], v[80:83], v[20:23]
  ds_read_b64_tr_b16 v[60:61], v98 offset:32
  ds_read_b64_tr_b16 v[62:63], v98 offset:672
  v_mfma_f32_16x16x32_bf16 v[40:43], v[156:159], v[80:83], v[40:43]
  ds_read_b64_tr_b16 v[64:65], v99 offset:0
  ds_read_b64_tr_b16 v[66:67], v99 offset:640
  v_mfma_f32_16x16x32_bf16 v[24:27], v[152:155], v[84:87], v[24:27]
  ds_read_b64_tr_b16 v[68:69], v100 offset:0
  ds_read_b64_tr_b16 v[70:71], v100 offset:640
  v_mfma_f32_16x16x32_bf16 v[44:47], v[156:159], v[84:87], v[44:47]
  ds_read_b64_tr_b16 v[72:73], v100 offset:32
  ds_read_b64_tr_b16 v[74:75], v100 offset:672
  v_mfma_f32_16x16x32_bf16 v[28:31], v[152:155], v[88:91], v[28:31]
  v_mfma_f32_16x16x32_bf16 v[48:51], v[156:159], v[88:91], v[48:51]
  v_mfma_f32_16x16x32_bf16 v[32:35], v[152:155], v[92:95], v[32:35]
  v_mfma_f32_16x16x32_bf16 v[52:55], v[156:159], v[92:95], v[52:55]
  s_waitcnt lgkmcnt(0)
  v_mfma_f32_16x16x32_bf16 v[16:19], v[160:163], v[56:59], v[16:19]
  ds_read_b128 v[168:171], v97 offset:0
  ds_read_b128 v[172:175], v97 offset:2048
  v_mfma_f32_16x16x32_bf16 v[36:39], v[164:167], v[56:59], v[36:39]
  ds_read_b64_tr_b16 v[76:77], v98 offset:5632
  ds_read_b64_tr_b16 v[78:79], v98 offset:6272
  v_mfma_f32_16x16x32_bf16 v[20:23], v[160:163], v[60:63], v[20:23]
  ds_read_b64_tr_b16 v[80:81], v98 offset:5664
  ds_read_b64_tr_b16 v[82:83], v98 offset:6304
  v_mfma_f32_16x16x32_bf16 v[40:43], v[164:167], v[60:63], v[40:43]
  ds_read_b64_tr_b16 v[84:85], v99 offset:5632
  ds_read_b64_tr_b16 v[86:87], v99 offset:6272
  v_mfma_f32_16x16x32_bf16 v[24:27], v[160:163], v[64:67], v[24:27]
  ds_read_b64_tr_b16 v[88:89], v100 offset:5632
  ds_read_b64_tr_b16 v[90:91], v100 offset:6272
  v_mfma_f32_16x16x32_bf16 v[44:47], v[164:167], v[64:67], v[44:47]
  ds_read_b64_tr_b16 v[92:93], v100 offset:5664
  ds_read_b64_tr_b16 v[94:95], v100 offset:6304
  v_mfma_f32_16x16x32_bf16 v[28:31], v[160:163], v[68:71], v[28:31]
  v_mfma_f32_16x16x32_bf16 v[48:51], v[164:167], v[68:71], v[48:51]
  v_mfma_f32_16x16x32_bf16 v[32:35], v[160:163], v[72:75], v[32:35]
  v_mfma_f32_16x16x32_bf16 v[52:55], v[164:167], v[72:75], v[52:55]
  s_waitcnt lgkmcnt(0)
  s_barrier
  v_mfma_f32_16x16x32_bf16 v[16:19], v[168:171], v[76:79], v[16:19]
  ds_read_b128 v[176:179], v96 offset:16384
  ds_read_b128 v[180:183], v96 offset:18432
  v_mfma_f32_16x16x32_bf16 v[36:39], v[172:175], v[76:79], v[36:39]
  ds_read_b64_tr_b16 v[56:57], v98 offset:11264
  ds_read_b64_tr_b16 v[58:59], v98 offset:11904
  v_mfma_f32_16x16x32_bf16 v[20:23], v[168:171], v[80:83], v[20:23]
  ds_read_b64_tr_b16 v[60:61], v98 offset:11296
  ds_read_b64_tr_b16 v[62:63], v98 offset:11936
  v_mfma_f32_16x16x32_bf16 v[40:43], v[172:175], v[80:83], v[40:43]
  ds_read_b64_tr_b16 v[64:65], v99 offset:11264
  ds_read_b64_tr_b16 v[66:67], v99 offset:11904
  v_mfma_f32_16x16x32_bf16 v[24:27], v[168:171], v[84:87], v[24:27]
  ds_read_b64_tr_b16 v[68:69], v100 offset:11264
  ds_read_b64_tr_b16 v[70:71], v100 offset:11904
  v_mfma_f32_16x16x32_bf16 v[44:47], v[172:175], v[84:87], v[44:47]
  ds_read_b64_tr_b16 v[72:73], v100 offset:11296
  ds_read_b64_tr_b16 v[74:75], v100 offset:11936
  v_mfma_f32_16x16x32_bf16 v[28:31], v[168:171], v[88:91], v[28:31]
  v_mfma_f32_16x16x32_bf16 v[48:51], v[172:175], v[88:91], v[48:51]
  v_mfma_f32_16x16x32_bf16 v[32:35], v[168:171], v[92:95], v[32:35]
  v_mfma_f32_16x16x32_bf16 v[52:55], v[172:175], v[92:95], v[52:55]
  s_waitcnt lgkmcnt(0)
  v_mfma_f32_16x16x32_bf16 v[16:19], v[176:179], v[56:59], v[16:19]
  ds_read_b128 v[184:187], v97 offset:16384
  ds_read_b128 v[188:191], v97 offset:18432
  v_mfma_f32_16x16x32_bf16 v[36:39], v[180:183], v[56:59], v[36:39]
  ds_read_b64_tr_b16 v[76:77], v98 offset:16896
  ds_read_b64_tr_b16 v[78:79], v98 offset:17536
  v_mfma_f32_16x16x32_bf16 v[20:23], v[176:179], v[60:63], v[20:23]
  ds_read_b64_tr_b16 v[80:81], v98 offset:16928
  ds_read_b64_tr_b16 v[82:83], v98 offset:17568
  v_mfma_f32_16x16x32_bf16 v[40:43], v[180:183], v[60:63], v[40:43]
  ds_read_b64_tr_b16 v[84:85], v99 offset:16896
  ds_read_b64_tr_b16 v[86:87], v99 offset:17536
  v_mfma_f32_16x16x32_bf16 v[24:27], v[176:179], v[64:67], v[24:27]
  ds_read_b64_tr_b16 v[88:89], v100 offset:16896
  ds_read_b64_tr_b16 v[90:91], v100 offset:17536
  v_mfma_f32_16x16x32_bf16 v[44:47], v[180:183], v[64:67], v[44:47]
  ds_read_b64_tr_b16 v[92:93], v100 offset:16928
  ds_read_b64_tr_b16 v[94:95], v100 offset:17568
  v_mfma_f32_16x16x32_bf16 v[28:31], v[176:179], v[68:71], v[28:31]
  v_mfma_f32_16x16x32_bf16 v[48:51], v[180:183], v[68:71], v[48:51]
  v_mfma_f32_16x16x32_bf16 v[32:35], v[176:179], v[72:75], v[32:35]
  v_mfma_f32_16x16x32_bf16 v[52:55], v[180:183], v[72:75], v[52:55]
  s_waitcnt lgkmcnt(0)
  s_barrier
  v_mfma_f32_16x16x32_bf16 v[16:19], v[184:187], v[76:79], v[16:19]
  ds_read_b128 v[192:195], v96 offset:32768
  ds_read_b128 v[196:199], v96 offset:34816
  v_mfma_f32_16x16x32_bf16 v[36:39], v[188:191], v[76:79], v[36:39]
  ds_read_b64_tr_b16 v[56:57], v98 offset:22528
  ds_read_b64_tr_b16 v[58:59], v98 offset:23168
  v_mfma_f32_16x16x32_bf16 v[20:23], v[184:187], v[80:83], v[20:23]
  ds_read_b64_tr_b16 v[60:61], v98 offset:22560
  ds_read_b64_tr_b16 v[62:63], v98 offset:23200
  v_mfma_f32_16x16x32_bf16 v[40:43], v[188:191], v[80:83], v[40:43]
  ds_read_b64_tr_b16 v[64:65], v99 offset:22528
  ds_read_b64_tr_b16 v[66:67], v99 offset:23168
  v_mfma_f32_16x16x32_bf16 v[24:27], v[184:187], v[84:87], v[24:27]
  ds_read_b64_tr_b16 v[68:69], v100 offset:22528
  ds_read_b64_tr_b16 v[70:71], v100 offset:23168
  v_mfma_f32_16x16x32_bf16 v[44:47], v[188:191], v[84:87], v[44:47]
  ds_read_b64_tr_b16 v[72:73], v100 offset:22560
  ds_read_b64_tr_b16 v[74:75], v100 offset:23200
  v_mfma_f32_16x16x32_bf16 v[28:31], v[184:187], v[88:91], v[28:31]
  v_mfma_f32_16x16x32_bf16 v[48:51], v[188:191], v[88:91], v[48:51]
  v_mfma_f32_16x16x32_bf16 v[32:35], v[184:187], v[92:95], v[32:35]
  v_mfma_f32_16x16x32_bf16 v[52:55], v[188:191], v[92:95], v[52:55]
  s_waitcnt lgkmcnt(0)
  v_mfma_f32_16x16x32_bf16 v[16:19], v[192:195], v[56:59], v[16:19]
  ds_read_b128 v[200:203], v97 offset:32768
  ds_read_b128 v[204:207], v97 offset:34816
  v_mfma_f32_16x16x32_bf16 v[36:39], v[196:199], v[56:59], v[36:39]
  ds_read_b64_tr_b16 v[76:77], v98 offset:28160
  ds_read_b64_tr_b16 v[78:79], v98 offset:28800
  v_mfma_f32_16x16x32_bf16 v[20:23], v[192:195], v[60:63], v[20:23]
  ds_read_b64_tr_b16 v[80:81], v98 offset:28192
  ds_read_b64_tr_b16 v[82:83], v98 offset:28832
  v_mfma_f32_16x16x32_bf16 v[40:43], v[196:199], v[60:63], v[40:43]
  ds_read_b64_tr_b16 v[84:85], v99 offset:28160
  ds_read_b64_tr_b16 v[86:87], v99 offset:28800
  v_mfma_f32_16x16x32_bf16 v[24:27], v[192:195], v[64:67], v[24:27]
  ds_read_b64_tr_b16 v[88:89], v100 offset:28160
  ds_read_b64_tr_b16 v[90:91], v100 offset:28800
  v_mfma_f32_16x16x32_bf16 v[44:47], v[196:199], v[64:67], v[44:47]
  ds_read_b64_tr_b16 v[92:93], v100 offset:28192
  ds_read_b64_tr_b16 v[94:95], v100 offset:28832
  v_mfma_f32_16x16x32_bf16 v[28:31], v[192:195], v[68:71], v[28:31]
  v_mfma_f32_16x16x32_bf16 v[48:51], v[196:199], v[68:71], v[48:51]
  v_mfma_f32_16x16x32_bf16 v[32:35], v[192:195], v[72:75], v[32:35]
  v_mfma_f32_16x16x32_bf16 v[52:55], v[196:199], v[72:75], v[52:55]
  s_waitcnt lgkmcnt(0)
  s_barrier
  v_mfma_f32_16x16x32_bf16 v[16:19], v[200:203], v[76:79], v[16:19]
  ds_read_b128 v[208:211], v96 offset:0
  ds_read_b128 v[212:215], v96 offset:2048
  v_mfma_f32_16x16x32_bf16 v[36:39], v[204:207], v[76:79], v[36:39]
  ds_read_b64_tr_b16 v[56:57], v98 offset:0
  ds_read_b64_tr_b16 v[58:59], v98 offset:640
  v_mfma_f32_16x16x32_bf16 v[20:23], v[200:203], v[80:83], v[20:23]
  ds_read_b64_tr_b16 v[60:61], v98 offset:32
  ds_read_b64_tr_b16 v[62:63], v98 offset:672
  v_mfma_f32_16x16x32_bf16 v[40:43], v[204:207], v[80:83], v[40:43]
  ds_read_b64_tr_b16 v[64:65], v99 offset:0
  ds_read_b64_tr_b16 v[66:67], v99 offset:640
  v_mfma_f32_16x16x32_bf16 v[24:27], v[200:203], v[84:87], v[24:27]
  ds_read_b64_tr_b16 v[68:69], v100 offset:0
  ds_read_b64_tr_b16 v[70:71], v100 offset:640
  v_mfma_f32_16x16x32_bf16 v[44:47], v[204:207], v[84:87], v[44:47]
  ds_read_b64_tr_b16 v[72:73], v100 offset:32
  ds_read_b64_tr_b16 v[74:75], v100 offset:672
  v_mfma_f32_16x16x32_bf16 v[28:31], v[200:203], v[88:91], v[28:31]
  v_mfma_f32_16x16x32_bf16 v[48:51], v[204:207], v[88:91], v[48:51]
  v_mfma_f32_16x16x32_bf16 v[32:35], v[200:203], v[92:95], v[32:35]
  v_mfma_f32_16x16x32_bf16 v[52:55], v[204:207], v[92:95], v[52:55]
  s_waitcnt lgkmcnt(0)
  v_mfma_f32_16x16x32_bf16 v[16:19], v[208:211], v[56:59], v[16:19]
  ds_read_b128 v[216:219], v97 offset:0
  ds_read_b128 v[220:223], v97 offset:2048
  v_mfma_f32_16x16x32_bf16 v[36:39], v[212:215], v[56:59], v[36:39]
  ds_read_b64_tr_b16 v[76:77], v98 offset:5632
  ds_read_b64_tr_b16 v[78:79], v98 offset:6272
  v_mfma_f32_16x16x32_bf16 v[20:23], v[208:211], v[60:63], v[20:23]
  ds_read_b64_tr_b16 v[80:81], v98 offset:5664
  ds_read_b64_tr_b16 v[82:83], v98 offset:6304
  v_mfma_f32_16x16x32_bf16 v[40:43], v[212:215], v[60:63], v[40:43]
  ds_read_b64_tr_b16 v[84:85], v99 offset:5632
  ds_read_b64_tr_b16 v[86:87], v99 offset:6272
  v_mfma_f32_16x16x32_bf16 v[24:27], v[208:211], v[64:67], v[24:27]
  ds_read_b64_tr_b16 v[88:89], v100 offset:5632
  ds_read_b64_tr_b16 v[90:91], v100 offset:6272
  v_mfma_f32_16x16x32_bf16 v[44:47], v[212:215], v[64:67], v[44:47]
  ds_read_b64_tr_b16 v[92:93], v100 offset:5664
  ds_read_b64_tr_b16 v[94:95], v100 offset:6304
  v_mfma_f32_16x16x32_bf16 v[28:31], v[208:211], v[68:71], v[28:31]
  v_mfma_f32_16x16x32_bf16 v[48:51], v[212:215], v[68:71], v[48:51]
  v_mfma_f32_16x16x32_bf16 v[32:35], v[208:211], v[72:75], v[32:35]
  v_mfma_f32_16x16x32_bf16 v[52:55], v[212:215], v[72:75], v[52:55]
  s_waitcnt lgkmcnt(0)
  s_barrier
  v_mfma_f32_16x16x32_bf16 v[16:19], v[216:219], v[76:79], v[16:19]
  ds_read_b128 v[224:227], v96 offset:16384
  ds_read_b128 v[228:231], v96 offset:18432
  v_mfma_f32_16x16x32_bf16 v[36:39], v[220:223], v[76:79], v[36:39]
  ds_read_b64_tr_b16 v[56:57], v98 offset:11264
  ds_read_b64_tr_b16 v[58:59], v98 offset:11904
  v_mfma_f32_16x16x32_bf16 v[20:23], v[216:219], v[80:83], v[20:23]
  ds_read_b64_tr_b16 v[60:61], v98 offset:11296
  ds_read_b64_tr_b16 v[62:63], v98 offset:11936
  v_mfma_f32_16x16x32_bf16 v[40:43], v[220:223], v[80:83], v[40:43]
  ds_read_b64_tr_b16 v[64:65], v99 offset:11264
  ds_read_b64_tr_b16 v[66:67], v99 offset:11904
  v_mfma_f32_16x16x32_bf16 v[24:27], v[216:219], v[84:87], v[24:27]
  ds_read_b64_tr_b16 v[68:69], v100 offset:11264
  ds_read_b64_tr_b16 v[70:71], v100 offset:11904
  v_mfma_f32_16x16x32_bf16 v[44:47], v[220:223], v[84:87], v[44:47]
  ds_read_b64_tr_b16 v[72:73], v100 offset:11296
  ds_read_b64_tr_b16 v[74:75], v100 offset:11936
  v_mfma_f32_16x16x32_bf16 v[28:31], v[216:219], v[88:91], v[28:31]
  v_mfma_f32_16x16x32_bf16 v[48:51], v[220:223], v[88:91], v[48:51]
  v_mfma_f32_16x16x32_bf16 v[32:35], v[216:219], v[92:95], v[32:35]
  v_mfma_f32_16x16x32_bf16 v[52:55], v[220:223], v[92:95], v[52:55]
  s_waitcnt lgkmcnt(0)
  v_mfma_f32_16x16x32_bf16 v[16:19], v[224:227], v[56:59], v[16:19]
  ds_read_b128 v[232:235], v97 offset:16384
  ds_read_b128 v[236:239], v97 offset:18432
  v_mfma_f32_16x16x32_bf16 v[36:39], v[228:231], v[56:59], v[36:39]
  ds_read_b64_tr_b16 v[76:77], v98 offset:16896
  ds_read_b64_tr_b16 v[78:79], v98 offset:17536
  v_mfma_f32_16x16x32_bf16 v[20:23], v[224:227], v[60:63], v[20:23]
  ds_read_b64_tr_b16 v[80:81], v98 offset:16928
  ds_read_b64_tr_b16 v[82:83], v98 offset:17568
  v_mfma_f32_16x16x32_bf16 v[40:43], v[228:231], v[60:63], v[40:43]
  ds_read_b64_tr_b16 v[84:85], v99 offset:16896
  ds_read_b64_tr_b16 v[86:87], v99 offset:17536
  v_mfma_f32_16x16x32_bf16 v[24:27], v[224:227], v[64:67], v[24:27]
  ds_read_b64_tr_b16 v[88:89], v100 offset:16896
  ds_read_b64_tr_b16 v[90:91], v100 offset:17536
  v_mfma_f32_16x16x32_bf16 v[44:47], v[228:231], v[64:67], v[44:47]
  ds_read_b64_tr_b16 v[92:93], v100 offset:16928
  ds_read_b64_tr_b16 v[94:95], v100 offset:17568
  v_mfma_f32_16x16x32_bf16 v[28:31], v[224:227], v[68:71], v[28:31]
  v_mfma_f32_16x16x32_bf16 v[48:51], v[228:231], v[68:71], v[48:51]
  v_mfma_f32_16x16x32_bf16 v[32:35], v[224:227], v[72:75], v[32:35]
  v_mfma_f32_16x16x32_bf16 v[52:55], v[228:231], v[72:75], v[52:55]
  s_waitcnt vmcnt(0)
  s_waitcnt lgkmcnt(0)
  s_barrier
  v_mfma_f32_16x16x32_bf16 v[16:19], v[232:235], v[76:79], v[16:19]
  ds_read_b128 v[240:243], v96 offset:32768
  ds_read_b128 v[244:247], v96 offset:34816
  v_mfma_f32_16x16x32_bf16 v[36:39], v[236:239], v[76:79], v[36:39]
  ds_read_b64_tr_b16 v[56:57], v98 offset:22528
  ds_read_b64_tr_b16 v[58:59], v98 offset:23168
  v_mfma_f32_16x16x32_bf16 v[20:23], v[232:235], v[80:83], v[20:23]
  ds_read_b64_tr_b16 v[60:61], v98 offset:22560
  ds_read_b64_tr_b16 v[62:63], v98 offset:23200
  v_mfma_f32_16x16x32_bf16 v[40:43], v[236:239], v[80:83], v[40:43]
  ds_read_b64_tr_b16 v[64:65], v99 offset:22528
  ds_read_b64_tr_b16 v[66:67], v99 offset:23168
  v_mfma_f32_16x16x32_bf16 v[24:27], v[232:235], v[84:87], v[24:27]
  ds_read_b64_tr_b16 v[68:69], v100 offset:22528
  ds_read_b64_tr_b16 v[70:71], v100 offset:23168
  v_mfma_f32_16x16x32_bf16 v[44:47], v[236:239], v[84:87], v[44:47]
  ds_read_b64_tr_b16 v[72:73], v100 offset:22560
  ds_read_b64_tr_b16 v[74:75], v100 offset:23200
  v_mfma_f32_16x16x32_bf16 v[28:31], v[232:235], v[88:91], v[28:31]
  v_mfma_f32_16x16x32_bf16 v[48:51], v[236:239], v[88:91], v[48:51]
  v_mfma_f32_16x16x32_bf16 v[32:35], v[232:235], v[92:95], v[32:35]
  v_mfma_f32_16x16x32_bf16 v[52:55], v[236:239], v[92:95], v[52:55]
  s_waitcnt lgkmcnt(0)
  v_mfma_f32_16x16x32_bf16 v[16:19], v[240:243], v[56:59], v[16:19]
  ds_read_b128 v[248:251], v97 offset:32768
  ds_read_b128 v[252:255], v97 offset:34816
  v_mfma_f32_16x16x32_bf16 v[36:39], v[244:247], v[56:59], v[36:39]
  ds_read_b64_tr_b16 v[76:77], v98 offset:28160
  ds_read_b64_tr_b16 v[78:79], v98 offset:28800
  v_mfma_f32_16x16x32_bf16 v[20:23], v[240:243], v[60:63], v[20:23]
  ds_read_b64_tr_b16 v[80:81], v98 offset:28192
  ds_read_b64_tr_b16 v[82:83], v98 offset:28832
  v_mfma_f32_16x16x32_bf16 v[40:43], v[244:247], v[60:63], v[40:43]
  ds_read_b64_tr_b16 v[84:85], v99 offset:28160
  ds_read_b64_tr_b16 v[86:87], v99 offset:28800
  v_mfma_f32_16x16x32_bf16 v[24:27], v[240:243], v[64:67], v[24:27]
  ds_read_b64_tr_b16 v[88:89], v100 offset:28160
  ds_read_b64_tr_b16 v[90:91], v100 offset:28800
  v_mfma_f32_16x16x32_bf16 v[44:47], v[244:247], v[64:67], v[44:47]
  ds_read_b64_tr_b16 v[92:93], v100 offset:28192
  ds_read_b64_tr_b16 v[94:95], v100 offset:28832
  v_mfma_f32_16x16x32_bf16 v[28:31], v[240:243], v[68:71], v[28:31]
  v_mfma_f32_16x16x32_bf16 v[48:51], v[244:247], v[68:71], v[48:51]
  v_mfma_f32_16x16x32_bf16 v[32:35], v[240:243], v[72:75], v[32:35]
  v_mfma_f32_16x16x32_bf16 v[52:55], v[244:247], v[72:75], v[52:55]
  s_waitcnt lgkmcnt(0)
  v_mfma_f32_16x16x32_bf16 v[16:19], v[248:251], v[76:79], v[16:19]
  v_mfma_f32_16x16x32_bf16 v[36:39], v[252:255], v[76:79], v[36:39]
  v_mfma_f32_16x16x32_bf16 v[20:23], v[248:251], v[80:83], v[20:23]
  v_mfma_f32_16x16x32_bf16 v[40:43], v[252:255], v[80:83], v[40:43]
  v_mfma_f32_16x16x32_bf16 v[24:27], v[248:251], v[84:87], v[24:27]
  v_mfma_f32_16x16x32_bf16 v[44:47], v[252:255], v[84:87], v[44:47]
  v_mfma_f32_16x16x32_bf16 v[28:31], v[248:251], v[88:91], v[28:31]
  v_mfma_f32_16x16x32_bf16 v[48:51], v[252:255], v[88:91], v[48:51]
  v_mfma_f32_16x16x32_bf16 v[32:35], v[248:251], v[92:95], v[32:35]
  v_mfma_f32_16x16x32_bf16 v[52:55], v[252:255], v[92:95], v[52:55]
  v_pk_mul_f32 v[80:81], v[16:17], s[62:63]
  v_pk_mul_f32 v[82:83], v[18:19], s[62:63]
  v_max_f32 v16, 0, v16
  v_exp_f32_e64 v80, v80 clamp
  v_max_f32 v17, 0, v17
  v_exp_f32_e64 v81, v81 clamp
  v_max_f32 v18, 0, v18
  v_exp_f32_e64 v82, v82 clamp
  v_max_f32 v19, 0, v19
  v_exp_f32_e64 v83, v83 clamp
  v_pk_add_f32 v[16:17], v[16:17], s[64:65]
  v_pk_add_f32 v[18:19], v[18:19], s[64:65]
  v_pk_add_f32 v[16:17], v[16:17], v[80:81]
  v_pk_add_f32 v[18:19], v[18:19], v[82:83]
  v_cvt_pk_bf16_f32 v56, v16, v17
  v_cvt_pk_bf16_f32 v57, v18, v19
  v_pk_mul_f32 v[80:81], v[36:37], s[62:63]
  v_pk_mul_f32 v[82:83], v[38:39], s[62:63]
  v_max_f32 v36, 0, v36
  v_exp_f32_e64 v80, v80 clamp
  v_max_f32 v37, 0, v37
  v_exp_f32_e64 v81, v81 clamp
  v_max_f32 v38, 0, v38
  v_exp_f32_e64 v82, v82 clamp
  v_max_f32 v39, 0, v39
  v_exp_f32_e64 v83, v83 clamp
  v_pk_add_f32 v[36:37], v[36:37], s[64:65]
  v_pk_add_f32 v[38:39], v[38:39], s[64:65]
  v_pk_add_f32 v[36:37], v[36:37], v[80:81]
  v_pk_add_f32 v[38:39], v[38:39], v[82:83]
  v_cvt_pk_bf16_f32 v58, v36, v37
  v_cvt_pk_bf16_f32 v59, v38, v39
  v_cvt_pk_bf16_f32 v68, v24, v25
  v_cvt_pk_bf16_f32 v69, v26, v27
  v_cvt_pk_bf16_f32 v70, v44, v45
  v_cvt_pk_bf16_f32 v71, v46, v47
  v_cvt_pk_bf16_f32 v72, v28, v29
  v_cvt_pk_bf16_f32 v73, v30, v31
  v_cvt_pk_bf16_f32 v74, v48, v49
  v_cvt_pk_bf16_f32 v75, v50, v51
  v_cvt_pk_bf16_f32 v76, v32, v33
  v_cvt_pk_bf16_f32 v77, v34, v35
  v_cvt_pk_bf16_f32 v78, v52, v53
  v_cvt_pk_bf16_f32 v79, v54, v55
  v_and_b32 v2, 15, v1
  v_cmp_eq_u32 vcc, 8, v2
  v_mov_b32 v3, 0x3f803f80
  s_nop 0
  v_cndmask_b32 v76, v76, v3, vcc
  v_cndmask_b32 v77, v77, v3, vcc
  v_cndmask_b32 v78, v78, v3, vcc
  v_cndmask_b32 v79, v79, v3, vcc
  v_mfma_f32_16x16x32_bf16 v[28:31], v[56:59], v[68:71], 0
  v_mfma_f32_16x16x32_bf16 v[32:35], v[56:59], v[72:75], 0
  v_mfma_f32_16x16x32_bf16 v[48:51], v[56:59], v[76:79], 0
  v_pk_mul_f32 v[80:81], v[20:21], s[62:63]
  v_pk_mul_f32 v[82:83], v[22:23], s[62:63]
  v_max_f32 v20, 0, v20
  v_exp_f32_e64 v80, v80 clamp
  v_max_f32 v21, 0, v21
  v_exp_f32_e64 v81, v81 clamp
  v_max_f32 v22, 0, v22
  v_exp_f32_e64 v82, v82 clamp
  v_max_f32 v23, 0, v23
  v_exp_f32_e64 v83, v83 clamp
  v_pk_add_f32 v[20:21], v[20:21], s[64:65]
  v_pk_add_f32 v[22:23], v[22:23], s[64:65]
  v_pk_add_f32 v[20:21], v[20:21], v[80:81]
  v_pk_add_f32 v[22:23], v[22:23], v[82:83]
  v_cvt_pk_bf16_f32 v60, v20, v21
  v_cvt_pk_bf16_f32 v61, v22, v23
  v_pk_mul_f32 v[80:81], v[40:41], s[62:63]
  v_pk_mul_f32 v[82:83], v[42:43], s[62:63]
  v_max_f32 v40, 0, v40
  v_exp_f32_e64 v80, v80 clamp
  v_max_f32 v41, 0, v41
  v_exp_f32_e64 v81, v81 clamp
  v_max_f32 v42, 0, v42
  v_exp_f32_e64 v82, v82 clamp
  v_max_f32 v43, 0, v43
  v_exp_f32_e64 v83, v83 clamp
  v_pk_add_f32 v[40:41], v[40:41], s[64:65]
  v_pk_add_f32 v[42:43], v[42:43], s[64:65]
  v_pk_add_f32 v[40:41], v[40:41], v[80:81]
  v_pk_add_f32 v[42:43], v[42:43], v[82:83]
  v_cvt_pk_bf16_f32 v62, v40, v41
  v_cvt_pk_bf16_f32 v63, v42, v43
  s_nop 1
  v_mfma_f32_16x16x32_bf16 v[52:55], v[60:63], v[68:71], 0
  v_mfma_f32_16x16x32_bf16 v[84:87], v[60:63], v[72:75], 0
  v_mfma_f32_16x16x32_bf16 v[88:91], v[60:63], v[76:79], 0
  ds_write_b128 v101, v[28:31]
  ds_write_b128 v102, v[32:35]
  ds_write_b128 v103, v[48:51]
  v_pk_mul_f32 v[80:81], v[24:25], s[62:63]
  v_pk_mul_f32 v[82:83], v[26:27], s[62:63]
  v_max_f32 v24, 0, v24
  v_exp_f32_e64 v80, v80 clamp
  v_max_f32 v25, 0, v25
  v_exp_f32_e64 v81, v81 clamp
  v_max_f32 v26, 0, v26
  v_exp_f32_e64 v82, v82 clamp
  v_max_f32 v27, 0, v27
  v_exp_f32_e64 v83, v83 clamp
  v_pk_add_f32 v[24:25], v[24:25], s[64:65]
  v_pk_add_f32 v[26:27], v[26:27], s[64:65]
  v_pk_add_f32 v[24:25], v[24:25], v[80:81]
  v_pk_add_f32 v[26:27], v[26:27], v[82:83]
  v_cvt_pk_bf16_f32 v64, v24, v25
  v_cvt_pk_bf16_f32 v65, v26, v27
  v_pk_mul_f32 v[80:81], v[44:45], s[62:63]
  v_pk_mul_f32 v[82:83], v[46:47], s[62:63]
  v_max_f32 v44, 0, v44
  v_exp_f32_e64 v80, v80 clamp
  v_max_f32 v45, 0, v45
  v_exp_f32_e64 v81, v81 clamp
  v_max_f32 v46, 0, v46
  v_exp_f32_e64 v82, v82 clamp
  v_max_f32 v47, 0, v47
  v_exp_f32_e64 v83, v83 clamp
  v_pk_add_f32 v[44:45], v[44:45], s[64:65]
  v_pk_add_f32 v[46:47], v[46:47], s[64:65]
  v_pk_add_f32 v[44:45], v[44:45], v[80:81]
  v_pk_add_f32 v[46:47], v[46:47], v[82:83]
  v_cvt_pk_bf16_f32 v66, v44, v45
  v_cvt_pk_bf16_f32 v67, v46, v47
  s_nop 1
  v_mfma_f32_16x16x32_bf16 v[92:95], v[64:67], v[72:75], 0
  v_mfma_f32_16x16x32_bf16 v[12:15], v[64:67], v[76:79], 0
  ds_write_b128 v104, v[52:55]
  ds_write_b128 v105, v[84:87]
  ds_write_b128 v106, v[88:91]
  s_nop 4
  ds_write_b128 v107, v[92:95]
  ds_write_b128 v108, v[12:15]
  v_mov_b32 v2, 107748
  v_mov_b32 v3, 1
  s_mov_b64 exec, 1
  ds_add_u32 v2, v3
  s_mov_b64 exec, -1
  s_mov_b32 s66, 0
  s_lshl_b32 s46, s45, 6
  v_add_u32 v24, s46, v1
  v_lshlrev_b32 v28, 4, v24
L_csync_18:
  ds_read_b32 v3, v2
  s_waitcnt lgkmcnt(0)
  v_readfirstlane_b32 s46, v3
  s_add_u32 s66, s66, 1
  s_cmp_gt_u32 s66, 1048576
  s_cbranch_scc1 L_csyncd_19
  s_cmp_lt_u32 s46, 4
  s_cbranch_scc1 L_csync_18
L_csyncd_19:
  s_cmp_eq_u32 s45, 3
  s_cbranch_scc1 L_nopub
  v_add_u32 v29, 92160, v28
  ds_read_b128 v[32:35], v29
  ds_read_b128 v[36:39], v29 offset:3072
  ds_read_b128 v[40:43], v29 offset:6144
  ds_read_b128 v[44:47], v29 offset:9216
  s_lshl_b32 s46, s37, 4
  s_add_u32 s46, s46, s36
  s_mul_i32 s46, s46, 3072
  s_add_u32 s46, s46, 65536
  v_cmp_gt_u32 vcc, 189, v24
  s_waitcnt lgkmcnt(2)
  v_pk_add_f32 v[32:33], v[32:33], v[36:37]
  v_pk_add_f32 v[34:35], v[34:35], v[38:39]
  s_waitcnt lgkmcnt(0)
  v_pk_add_f32 v[40:41], v[40:41], v[44:45]
  v_pk_add_f32 v[42:43], v[42:43], v[46:47]
  v_pk_add_f32 v[32:33], v[32:33], v[40:41]
  v_pk_add_f32 v[34:35], v[34:35], v[42:43]
  s_and_saveexec_b64 s[68:69], vcc
  v_min_u32 v32, -2, v32
  v_min_u32 v33, -2, v33
  v_min_u32 v34, -2, v34
  v_min_u32 v35, -2, v35
  buffer_store_dwordx4 v[32:35], v28, s[32:35], s46 offen sc1

  s_lshl_b32 s46, s37, 2
  s_add_u32 s46, s46, s45
  s_lshl_b32 s46, s46, 4
  s_add_u32 s46, s46, s36
  s_lshl_b32 s46, s46, 6
  s_add_u32 s46, s46, 3407872
  v_mov_b32 v36, s41
  v_mov_b32 v37, s41
  v_mov_b32 v38, s41
  v_mov_b32 v39, s41
  v_lshlrev_b32 v40, 4, v1
  s_mov_b64 exec, 0xf
  buffer_store_dwordx4 v[36:39], v40, s[32:35], s46 offen sc1
  s_mov_b64 exec, -1
L_nopub:
  v_mov_b32 v2, 107752
  s_mov_b32 s66, 0
L_wqd_20:
  ds_read_b32 v3, v2
  s_waitcnt lgkmcnt(0)
  v_readfirstlane_b32 s12, v3
  s_add_u32 s66, s66, 1
  s_cmp_gt_u32 s66, 1048576
  s_cbranch_scc1 L_wqdd_21
  s_cmp_ge_u32 s12, 4
  s_cbranch_scc1 L_wqdd_21

  s_branch L_wqd_20
L_wqdd_21:
  v_mov_b32 v16, 0
  v_mov_b32 v17, 0
  v_mov_b32 v18, 0
  v_mov_b32 v19, 0
  v_mov_b32 v20, 0
  v_mov_b32 v21, 0
  v_mov_b32 v22, 0
  v_mov_b32 v23, 0
  v_mov_b32 v24, 0
  v_mov_b32 v25, 0
  v_mov_b32 v26, 0
  v_mov_b32 v27, 0
  v_mov_b32 v28, 0
  v_mov_b32 v29, 0
  v_mov_b32 v30, 0
  v_mov_b32 v31, 0
  v_mov_b32 v32, 0
  v_mov_b32 v33, 0
  v_mov_b32 v34, 0
  v_mov_b32 v35, 0
  v_mov_b32 v36, 0
  v_mov_b32 v37, 0
  v_mov_b32 v38, 0
  v_mov_b32 v39, 0
  s_mov_b32 s60, s40
  s_mul_i32 s46, s60, 5632
  v_add_u32 v110, s46, v109
  s_add_u32 s60, s60, 1
  s_cmp_eq_u32 s60, 9
  s_cselect_b32 s60, 0, s60
  ds_read_b64_tr_b16 v[56:57], v110 offset:0
  ds_read_b64_tr_b16 v[58:59], v110 offset:640
  ds_read_b64_tr_b16 v[60:61], v110 offset:32
  ds_read_b64_tr_b16 v[62:63], v110 offset:672
  ds_read_b64_tr_b16 v[64:65], v110 offset:64
  ds_read_b64_tr_b16 v[66:67], v110 offset:704
  ds_read_b64_tr_b16 v[68:69], v110 offset:80
  ds_read_b64_tr_b16 v[70:71], v110 offset:720
  ds_read_b64_tr_b16 v[72:73], v110 offset:112
  ds_read_b64_tr_b16 v[74:75], v110 offset:752
  ds_read_b64_tr_b16 v[76:77], v110 offset:144
  ds_read_b64_tr_b16 v[78:79], v110 offset:784
  s_mul_i32 s46, s60, 5632
  v_add_u32 v111, s46, v109
  s_add_u32 s60, s60, 1
  s_cmp_eq_u32 s60, 9
  s_cselect_b32 s60, 0, s60
  s_waitcnt lgkmcnt(6)
  v_mfma_f32_16x16x32_bf16 v[16:19], v[56:59], v[112:115], v[16:19]
  ds_read_b64_tr_b16 v[80:81], v111 offset:0
  v_mfma_f32_16x16x32_bf16 v[20:23], v[56:59], v[116:119], v[20:23]
  ds_read_b64_tr_b16 v[82:83], v111 offset:640
  v_mfma_f32_16x16x32_bf16 v[24:27], v[60:63], v[112:115], v[24:27]
  ds_read_b64_tr_b16 v[84:85], v111 offset:32
  v_mfma_f32_16x16x32_bf16 v[28:31], v[60:63], v[116:119], v[28:31]
  ds_read_b64_tr_b16 v[86:87], v111 offset:672
  v_mfma_f32_16x16x32_bf16 v[32:35], v[64:67], v[112:115], v[32:35]
  ds_read_b64_tr_b16 v[88:89], v111 offset:64
  v_mfma_f32_16x16x32_bf16 v[36:39], v[64:67], v[116:119], v[36:39]
  ds_read_b64_tr_b16 v[90:91], v111 offset:704
  s_waitcnt lgkmcnt(6)
  v_mfma_f32_16x16x32_bf16 v[16:19], v[68:71], v[120:123], v[16:19]
  ds_read_b64_tr_b16 v[56:57], v111 offset:80
  v_mfma_f32_16x16x32_bf16 v[20:23], v[68:71], v[124:127], v[20:23]
  ds_read_b64_tr_b16 v[58:59], v111 offset:720
  v_mfma_f32_16x16x32_bf16 v[24:27], v[72:75], v[120:123], v[24:27]
  ds_read_b64_tr_b16 v[60:61], v111 offset:112
  v_mfma_f32_16x16x32_bf16 v[28:31], v[72:75], v[124:127], v[28:31]
  ds_read_b64_tr_b16 v[62:63], v111 offset:752
  v_mfma_f32_16x16x32_bf16 v[32:35], v[76:79], v[120:123], v[32:35]
  ds_read_b64_tr_b16 v[64:65], v111 offset:144
  v_mfma_f32_16x16x32_bf16 v[36:39], v[76:79], v[124:127], v[36:39]
  ds_read_b64_tr_b16 v[66:67], v111 offset:784
  s_mul_i32 s46, s60, 5632
  v_add_u32 v110, s46, v109
  s_add_u32 s60, s60, 1
  s_cmp_eq_u32 s60, 9
  s_cselect_b32 s60, 0, s60
  s_waitcnt lgkmcnt(6)
  v_mfma_f32_16x16x32_bf16 v[16:19], v[80:83], v[128:131], v[16:19]
  ds_read_b64_tr_b16 v[68:69], v110 offset:0
  v_mfma_f32_16x16x32_bf16 v[20:23], v[80:83], v[132:135], v[20:23]
  ds_read_b64_tr_b16 v[70:71], v110 offset:640
  v_mfma_f32_16x16x32_bf16 v[24:27], v[84:87], v[128:131], v[24:27]
  ds_read_b64_tr_b16 v[72:73], v110 offset:32
  v_mfma_f32_16x16x32_bf16 v[28:31], v[84:87], v[132:135], v[28:31]
  ds_read_b64_tr_b16 v[74:75], v110 offset:672
  v_mfma_f32_16x16x32_bf16 v[32:35], v[88:91], v[128:131], v[32:35]
  ds_read_b64_tr_b16 v[76:77], v110 offset:64
  v_mfma_f32_16x16x32_bf16 v[36:39], v[88:91], v[132:135], v[36:39]
  ds_read_b64_tr_b16 v[78:79], v110 offset:704
  s_waitcnt lgkmcnt(6)
  v_mfma_f32_16x16x32_bf16 v[16:19], v[56:59], v[136:139], v[16:19]
  ds_read_b64_tr_b16 v[80:81], v110 offset:80
  v_mfma_f32_16x16x32_bf16 v[20:23], v[56:59], v[140:143], v[20:23]
  ds_read_b64_tr_b16 v[82:83], v110 offset:720
  v_mfma_f32_16x16x32_bf16 v[24:27], v[60:63], v[136:139], v[24:27]
  ds_read_b64_tr_b16 v[84:85], v110 offset:112
  v_mfma_f32_16x16x32_bf16 v[28:31], v[60:63], v[140:143], v[28:31]
  ds_read_b64_tr_b16 v[86:87], v110 offset:752
  v_mfma_f32_16x16x32_bf16 v[32:35], v[64:67], v[136:139], v[32:35]
  ds_read_b64_tr_b16 v[88:89], v110 offset:144
  v_mfma_f32_16x16x32_bf16 v[36:39], v[64:67], v[140:143], v[36:39]
  ds_read_b64_tr_b16 v[90:91], v110 offset:784
  s_mul_i32 s46, s60, 5632
  v_add_u32 v111, s46, v109
  s_add_u32 s60, s60, 1
  s_cmp_eq_u32 s60, 9
  s_cselect_b32 s60, 0, s60
  s_waitcnt lgkmcnt(6)
  v_mfma_f32_16x16x32_bf16 v[16:19], v[68:71], v[144:147], v[16:19]
  ds_read_b64_tr_b16 v[56:57], v111 offset:0
  v_mfma_f32_16x16x32_bf16 v[20:23], v[68:71], v[148:151], v[20:23]
  ds_read_b64_tr_b16 v[58:59], v111 offset:640
  v_mfma_f32_16x16x32_bf16 v[24:27], v[72:75], v[144:147], v[24:27]
  ds_read_b64_tr_b16 v[60:61], v111 offset:32
  v_mfma_f32_16x16x32_bf16 v[28:31], v[72:75], v[148:151], v[28:31]
  ds_read_b64_tr_b16 v[62:63], v111 offset:672
  v_mfma_f32_16x16x32_bf16 v[32:35], v[76:79], v[144:147], v[32:35]
  ds_read_b64_tr_b16 v[64:65], v111 offset:64
  v_mfma_f32_16x16x32_bf16 v[36:39], v[76:79], v[148:151], v[36:39]
  ds_read_b64_tr_b16 v[66:67], v111 offset:704
  s_waitcnt lgkmcnt(6)
  v_mfma_f32_16x16x32_bf16 v[16:19], v[80:83], v[152:155], v[16:19]
  ds_read_b64_tr_b16 v[68:69], v111 offset:80
  v_mfma_f32_16x16x32_bf16 v[20:23], v[80:83], v[156:159], v[20:23]
  ds_read_b64_tr_b16 v[70:71], v111 offset:720
  v_mfma_f32_16x16x32_bf16 v[24:27], v[84:87], v[152:155], v[24:27]
  ds_read_b64_tr_b16 v[72:73], v111 offset:112
  v_mfma_f32_16x16x32_bf16 v[28:31], v[84:87], v[156:159], v[28:31]
  ds_read_b64_tr_b16 v[74:75], v111 offset:752
  v_mfma_f32_16x16x32_bf16 v[32:35], v[88:91], v[152:155], v[32:35]
  ds_read_b64_tr_b16 v[76:77], v111 offset:144
  v_mfma_f32_16x16x32_bf16 v[36:39], v[88:91], v[156:159], v[36:39]
  ds_read_b64_tr_b16 v[78:79], v111 offset:784
  s_mul_i32 s46, s60, 5632
  v_add_u32 v110, s46, v109
  s_add_u32 s60, s60, 1
  s_cmp_eq_u32 s60, 9
  s_cselect_b32 s60, 0, s60
  s_waitcnt lgkmcnt(6)
  v_mfma_f32_16x16x32_bf16 v[16:19], v[56:59], v[160:163], v[16:19]
  ds_read_b64_tr_b16 v[80:81], v110 offset:0
  v_mfma_f32_16x16x32_bf16 v[20:23], v[56:59], v[164:167], v[20:23]
  ds_read_b64_tr_b16 v[82:83], v110 offset:640
  v_mfma_f32_16x16x32_bf16 v[24:27], v[60:63], v[160:163], v[24:27]
  ds_read_b64_tr_b16 v[84:85], v110 offset:32
  v_mfma_f32_16x16x32_bf16 v[28:31], v[60:63], v[164:167], v[28:31]
  ds_read_b64_tr_b16 v[86:87], v110 offset:672
  v_mfma_f32_16x16x32_bf16 v[32:35], v[64:67], v[160:163], v[32:35]
  ds_read_b64_tr_b16 v[88:89], v110 offset:64
  v_mfma_f32_16x16x32_bf16 v[36:39], v[64:67], v[164:167], v[36:39]
  ds_read_b64_tr_b16 v[90:91], v110 offset:704
  s_waitcnt lgkmcnt(6)
  v_mfma_f32_16x16x32_bf16 v[16:19], v[68:71], v[168:171], v[16:19]
  ds_read_b64_tr_b16 v[56:57], v110 offset:80
  v_mfma_f32_16x16x32_bf16 v[20:23], v[68:71], v[172:175], v[20:23]
  ds_read_b64_tr_b16 v[58:59], v110 offset:720
  v_mfma_f32_16x16x32_bf16 v[24:27], v[72:75], v[168:171], v[24:27]
  ds_read_b64_tr_b16 v[60:61], v110 offset:112
  v_mfma_f32_16x16x32_bf16 v[28:31], v[72:75], v[172:175], v[28:31]
  ds_read_b64_tr_b16 v[62:63], v110 offset:752
  v_mfma_f32_16x16x32_bf16 v[32:35], v[76:79], v[168:171], v[32:35]
  ds_read_b64_tr_b16 v[64:65], v110 offset:144
  v_mfma_f32_16x16x32_bf16 v[36:39], v[76:79], v[172:175], v[36:39]
  ds_read_b64_tr_b16 v[66:67], v110 offset:784
  s_mul_i32 s46, s60, 5632
  v_add_u32 v111, s46, v109
  s_add_u32 s60, s60, 1
  s_cmp_eq_u32 s60, 9
  s_cselect_b32 s60, 0, s60
  s_waitcnt lgkmcnt(6)
  v_mfma_f32_16x16x32_bf16 v[16:19], v[80:83], v[176:179], v[16:19]
  ds_read_b64_tr_b16 v[68:69], v111 offset:0
  v_mfma_f32_16x16x32_bf16 v[20:23], v[80:83], v[180:183], v[20:23]
  ds_read_b64_tr_b16 v[70:71], v111 offset:640
  v_mfma_f32_16x16x32_bf16 v[24:27], v[84:87], v[176:179], v[24:27]
  ds_read_b64_tr_b16 v[72:73], v111 offset:32
  v_mfma_f32_16x16x32_bf16 v[28:31], v[84:87], v[180:183], v[28:31]
  ds_read_b64_tr_b16 v[74:75], v111 offset:672
  v_mfma_f32_16x16x32_bf16 v[32:35], v[88:91], v[176:179], v[32:35]
  ds_read_b64_tr_b16 v[76:77], v111 offset:64
  v_mfma_f32_16x16x32_bf16 v[36:39], v[88:91], v[180:183], v[36:39]
  ds_read_b64_tr_b16 v[78:79], v111 offset:704
  s_waitcnt lgkmcnt(6)
  v_mfma_f32_16x16x32_bf16 v[16:19], v[56:59], v[184:187], v[16:19]
  ds_read_b64_tr_b16 v[80:81], v111 offset:80
  v_mfma_f32_16x16x32_bf16 v[20:23], v[56:59], v[188:191], v[20:23]
  ds_read_b64_tr_b16 v[82:83], v111 offset:720
  v_mfma_f32_16x16x32_bf16 v[24:27], v[60:63], v[184:187], v[24:27]
  ds_read_b64_tr_b16 v[84:85], v111 offset:112
  v_mfma_f32_16x16x32_bf16 v[28:31], v[60:63], v[188:191], v[28:31]
  ds_read_b64_tr_b16 v[86:87], v111 offset:752
  v_mfma_f32_16x16x32_bf16 v[32:35], v[64:67], v[184:187], v[32:35]
  ds_read_b64_tr_b16 v[88:89], v111 offset:144
  v_mfma_f32_16x16x32_bf16 v[36:39], v[64:67], v[188:191], v[36:39]
  ds_read_b64_tr_b16 v[90:91], v111 offset:784
  s_mul_i32 s46, s60, 5632
  v_add_u32 v110, s46, v109
  s_add_u32 s60, s60, 1
  s_cmp_eq_u32 s60, 9
  s_cselect_b32 s60, 0, s60
  s_waitcnt lgkmcnt(6)
  v_mfma_f32_16x16x32_bf16 v[16:19], v[68:71], v[192:195], v[16:19]
  ds_read_b64_tr_b16 v[56:57], v110 offset:0
  v_mfma_f32_16x16x32_bf16 v[20:23], v[68:71], v[196:199], v[20:23]
  ds_read_b64_tr_b16 v[58:59], v110 offset:640
  v_mfma_f32_16x16x32_bf16 v[24:27], v[72:75], v[192:195], v[24:27]
  ds_read_b64_tr_b16 v[60:61], v110 offset:32
  v_mfma_f32_16x16x32_bf16 v[28:31], v[72:75], v[196:199], v[28:31]
  ds_read_b64_tr_b16 v[62:63], v110 offset:672
  v_mfma_f32_16x16x32_bf16 v[32:35], v[76:79], v[192:195], v[32:35]
  ds_read_b64_tr_b16 v[64:65], v110 offset:64
  v_mfma_f32_16x16x32_bf16 v[36:39], v[76:79], v[196:199], v[36:39]
  ds_read_b64_tr_b16 v[66:67], v110 offset:704
  s_waitcnt lgkmcnt(6)
  v_mfma_f32_16x16x32_bf16 v[16:19], v[80:83], v[200:203], v[16:19]
  ds_read_b64_tr_b16 v[68:69], v110 offset:80
  v_mfma_f32_16x16x32_bf16 v[20:23], v[80:83], v[204:207], v[20:23]
  ds_read_b64_tr_b16 v[70:71], v110 offset:720
  v_mfma_f32_16x16x32_bf16 v[24:27], v[84:87], v[200:203], v[24:27]
  ds_read_b64_tr_b16 v[72:73], v110 offset:112
  v_mfma_f32_16x16x32_bf16 v[28:31], v[84:87], v[204:207], v[28:31]
  ds_read_b64_tr_b16 v[74:75], v110 offset:752
  v_mfma_f32_16x16x32_bf16 v[32:35], v[88:91], v[200:203], v[32:35]
  ds_read_b64_tr_b16 v[76:77], v110 offset:144
  v_mfma_f32_16x16x32_bf16 v[36:39], v[88:91], v[204:207], v[36:39]
  ds_read_b64_tr_b16 v[78:79], v110 offset:784
  s_mul_i32 s46, s60, 5632
  v_add_u32 v111, s46, v109
  s_add_u32 s60, s60, 1
  s_cmp_eq_u32 s60, 9
  s_cselect_b32 s60, 0, s60
  s_waitcnt lgkmcnt(6)
  v_mfma_f32_16x16x32_bf16 v[16:19], v[56:59], v[208:211], v[16:19]
  ds_read_b64_tr_b16 v[80:81], v111 offset:0
  v_mfma_f32_16x16x32_bf16 v[20:23], v[56:59], v[212:215], v[20:23]
  ds_read_b64_tr_b16 v[82:83], v111 offset:640
  v_mfma_f32_16x16x32_bf16 v[24:27], v[60:63], v[208:211], v[24:27]
  ds_read_b64_tr_b16 v[84:85], v111 offset:32
  v_mfma_f32_16x16x32_bf16 v[28:31], v[60:63], v[212:215], v[28:31]
  ds_read_b64_tr_b16 v[86:87], v111 offset:672
  v_mfma_f32_16x16x32_bf16 v[32:35], v[64:67], v[208:211], v[32:35]
  ds_read_b64_tr_b16 v[88:89], v111 offset:64
  v_mfma_f32_16x16x32_bf16 v[36:39], v[64:67], v[212:215], v[36:39]
  ds_read_b64_tr_b16 v[90:91], v111 offset:704
  s_waitcnt lgkmcnt(6)
  v_mfma_f32_16x16x32_bf16 v[16:19], v[68:71], v[216:219], v[16:19]
  ds_read_b64_tr_b16 v[56:57], v111 offset:80
  v_mfma_f32_16x16x32_bf16 v[20:23], v[68:71], v[220:223], v[20:23]
  ds_read_b64_tr_b16 v[58:59], v111 offset:720
  v_mfma_f32_16x16x32_bf16 v[24:27], v[72:75], v[216:219], v[24:27]
  ds_read_b64_tr_b16 v[60:61], v111 offset:112
  v_mfma_f32_16x16x32_bf16 v[28:31], v[72:75], v[220:223], v[28:31]
  ds_read_b64_tr_b16 v[62:63], v111 offset:752
  v_mfma_f32_16x16x32_bf16 v[32:35], v[76:79], v[216:219], v[32:35]
  ds_read_b64_tr_b16 v[64:65], v111 offset:144
  v_mfma_f32_16x16x32_bf16 v[36:39], v[76:79], v[220:223], v[36:39]
  ds_read_b64_tr_b16 v[66:67], v111 offset:784
  s_mul_i32 s46, s60, 5632
  v_add_u32 v110, s46, v109
  s_add_u32 s60, s60, 1
  s_cmp_eq_u32 s60, 9
  s_cselect_b32 s60, 0, s60
  s_waitcnt lgkmcnt(6)
  v_mfma_f32_16x16x32_bf16 v[16:19], v[80:83], v[224:227], v[16:19]
  ds_read_b64_tr_b16 v[68:69], v110 offset:0
  v_mfma_f32_16x16x32_bf16 v[20:23], v[80:83], v[228:231], v[20:23]
  ds_read_b64_tr_b16 v[70:71], v110 offset:640
  v_mfma_f32_16x16x32_bf16 v[24:27], v[84:87], v[224:227], v[24:27]
  ds_read_b64_tr_b16 v[72:73], v110 offset:32
  v_mfma_f32_16x16x32_bf16 v[28:31], v[84:87], v[228:231], v[28:31]
  ds_read_b64_tr_b16 v[74:75], v110 offset:672
  v_mfma_f32_16x16x32_bf16 v[32:35], v[88:91], v[224:227], v[32:35]
  ds_read_b64_tr_b16 v[76:77], v110 offset:64
  v_mfma_f32_16x16x32_bf16 v[36:39], v[88:91], v[228:231], v[36:39]
  ds_read_b64_tr_b16 v[78:79], v110 offset:704
  s_waitcnt lgkmcnt(6)
  v_mfma_f32_16x16x32_bf16 v[16:19], v[56:59], v[232:235], v[16:19]
  ds_read_b64_tr_b16 v[80:81], v110 offset:80
  v_mfma_f32_16x16x32_bf16 v[20:23], v[56:59], v[236:239], v[20:23]
  ds_read_b64_tr_b16 v[82:83], v110 offset:720
  v_mfma_f32_16x16x32_bf16 v[24:27], v[60:63], v[232:235], v[24:27]
  ds_read_b64_tr_b16 v[84:85], v110 offset:112
  v_mfma_f32_16x16x32_bf16 v[28:31], v[60:63], v[236:239], v[28:31]
  ds_read_b64_tr_b16 v[86:87], v110 offset:752
  v_mfma_f32_16x16x32_bf16 v[32:35], v[64:67], v[232:235], v[32:35]
  ds_read_b64_tr_b16 v[88:89], v110 offset:144
  v_mfma_f32_16x16x32_bf16 v[36:39], v[64:67], v[236:239], v[36:39]
  ds_read_b64_tr_b16 v[90:91], v110 offset:784
  s_waitcnt lgkmcnt(6)
  v_mfma_f32_16x16x32_bf16 v[16:19], v[68:71], v[240:243], v[16:19]
  v_mfma_f32_16x16x32_bf16 v[20:23], v[68:71], v[244:247], v[20:23]
  v_mfma_f32_16x16x32_bf16 v[24:27], v[72:75], v[240:243], v[24:27]
  v_mfma_f32_16x16x32_bf16 v[28:31], v[72:75], v[244:247], v[28:31]
  v_mfma_f32_16x16x32_bf16 v[32:35], v[76:79], v[240:243], v[32:35]
  v_mfma_f32_16x16x32_bf16 v[36:39], v[76:79], v[244:247], v[36:39]
  s_waitcnt lgkmcnt(0)
  v_mfma_f32_16x16x32_bf16 v[16:19], v[80:83], v[248:251], v[16:19]
  v_mfma_f32_16x16x32_bf16 v[20:23], v[80:83], v[252:255], v[20:23]
  v_mfma_f32_16x16x32_bf16 v[24:27], v[84:87], v[248:251], v[24:27]
  v_mfma_f32_16x16x32_bf16 v[28:31], v[84:87], v[252:255], v[28:31]
  v_mfma_f32_16x16x32_bf16 v[32:35], v[88:91], v[248:251], v[32:35]
  v_mfma_f32_16x16x32_bf16 v[36:39], v[88:91], v[252:255], v[36:39]
  s_nop 3
  v_mov_b32 v2, 107772
  s_mov_b32 s66, 0
L_wpz_22:
  ds_read_b32 v3, v2
  s_waitcnt lgkmcnt(0)
  v_readfirstlane_b32 s12, v3
  s_add_u32 s66, s66, 1
  s_cmp_gt_u32 s66, 1048576
  s_cbranch_scc1 L_wpzd_23
  s_cmp_ge_u32 s12, 4
  s_cbranch_scc1 L_wpzd_23

  s_branch L_wpz_22
L_wpzd_23:
  v_pk_mul_f32 v[80:81], v[16:17], s[62:63]
  v_pk_mul_f32 v[82:83], v[18:19], s[62:63]
  v_max_f32 v16, 0, v16
  v_exp_f32_e64 v80, v80 clamp
  v_max_f32 v17, 0, v17
  v_exp_f32_e64 v81, v81 clamp
  v_max_f32 v18, 0, v18
  v_exp_f32_e64 v82, v82 clamp
  v_max_f32 v19, 0, v19
  v_exp_f32_e64 v83, v83 clamp
  v_pk_add_f32 v[16:17], v[16:17], s[64:65]
  v_pk_add_f32 v[18:19], v[18:19], s[64:65]
  v_pk_add_f32 v[16:17], v[16:17], v[80:81]
  v_pk_add_f32 v[18:19], v[18:19], v[82:83]
  v_cvt_pk_bf16_f32 v40, v16, v17
  v_cvt_pk_bf16_f32 v41, v18, v19
  v_pk_mul_f32 v[84:85], v[24:25], s[62:63]
  v_pk_mul_f32 v[86:87], v[26:27], s[62:63]
  v_max_f32 v24, 0, v24
  v_exp_f32_e64 v84, v84 clamp
  v_max_f32 v25, 0, v25
  v_exp_f32_e64 v85, v85 clamp
  v_max_f32 v26, 0, v26
  v_exp_f32_e64 v86, v86 clamp
  v_max_f32 v27, 0, v27
  v_exp_f32_e64 v87, v87 clamp
  v_pk_add_f32 v[24:25], v[24:25], s[64:65]
  v_pk_add_f32 v[26:27], v[26:27], s[64:65]
  v_pk_add_f32 v[24:25], v[24:25], v[84:85]
  v_pk_add_f32 v[26:27], v[26:27], v[86:87]
  v_cvt_pk_bf16_f32 v42, v24, v25
  v_cvt_pk_bf16_f32 v43, v26, v27
  v_pk_mul_f32 v[80:81], v[32:33], s[62:63]
  v_pk_mul_f32 v[82:83], v[34:35], s[62:63]
  v_max_f32 v32, 0, v32
  v_exp_f32_e64 v80, v80 clamp
  v_max_f32 v33, 0, v33
  v_exp_f32_e64 v81, v81 clamp
  v_max_f32 v34, 0, v34
  v_exp_f32_e64 v82, v82 clamp
  v_max_f32 v35, 0, v35
  v_exp_f32_e64 v83, v83 clamp
  v_pk_add_f32 v[32:33], v[32:33], s[64:65]
  v_pk_add_f32 v[34:35], v[34:35], s[64:65]
  v_pk_add_f32 v[32:33], v[32:33], v[80:81]
  v_pk_add_f32 v[34:35], v[34:35], v[82:83]
  v_cvt_pk_bf16_f32 v48, v32, v33
  v_cvt_pk_bf16_f32 v49, v34, v35
  v_pk_mul_f32 v[80:81], v[20:21], s[62:63]
  v_pk_mul_f32 v[82:83], v[22:23], s[62:63]
  v_max_f32 v20, 0, v20
  v_exp_f32_e64 v80, v80 clamp
  v_max_f32 v21, 0, v21
  v_exp_f32_e64 v81, v81 clamp
  v_max_f32 v22, 0, v22
  v_exp_f32_e64 v82, v82 clamp
  v_max_f32 v23, 0, v23
  v_exp_f32_e64 v83, v83 clamp
  v_pk_add_f32 v[20:21], v[20:21], s[64:65]
  v_pk_add_f32 v[22:23], v[22:23], s[64:65]
  v_pk_add_f32 v[20:21], v[20:21], v[80:81]
  v_pk_add_f32 v[22:23], v[22:23], v[82:83]
  v_cvt_pk_bf16_f32 v44, v20, v21
  v_cvt_pk_bf16_f32 v45, v22, v23
  v_pk_mul_f32 v[84:85], v[28:29], s[62:63]
  v_pk_mul_f32 v[86:87], v[30:31], s[62:63]
  v_max_f32 v28, 0, v28
  v_exp_f32_e64 v84, v84 clamp
  v_max_f32 v29, 0, v29
  v_exp_f32_e64 v85, v85 clamp
  v_max_f32 v30, 0, v30
  v_exp_f32_e64 v86, v86 clamp
  v_max_f32 v31, 0, v31
  v_exp_f32_e64 v87, v87 clamp
  v_pk_add_f32 v[28:29], v[28:29], s[64:65]
  v_pk_add_f32 v[30:31], v[30:31], s[64:65]
  v_pk_add_f32 v[28:29], v[28:29], v[84:85]
  v_pk_add_f32 v[30:31], v[30:31], v[86:87]
  v_cvt_pk_bf16_f32 v46, v28, v29
  v_cvt_pk_bf16_f32 v47, v30, v31
  v_pk_mul_f32 v[80:81], v[36:37], s[62:63]
  v_pk_mul_f32 v[82:83], v[38:39], s[62:63]
  v_max_f32 v36, 0, v36
  v_exp_f32_e64 v80, v80 clamp
  v_max_f32 v37, 0, v37
  v_exp_f32_e64 v81, v81 clamp
  v_max_f32 v38, 0, v38
  v_exp_f32_e64 v82, v82 clamp
  v_max_f32 v39, 0, v39
  v_exp_f32_e64 v83, v83 clamp
  v_pk_add_f32 v[36:37], v[36:37], s[64:65]
  v_pk_add_f32 v[38:39], v[38:39], s[64:65]
  v_pk_add_f32 v[36:37], v[36:37], v[80:81]
  v_pk_add_f32 v[38:39], v[38:39], v[82:83]
  v_cvt_pk_bf16_f32 v52, v36, v37
  v_cvt_pk_bf16_f32 v53, v38, v39
  v_cmp_gt_u32 vcc, 16, v1
  v_mov_b32 v50, 0
  v_mov_b32 v51, 0
  v_mov_b32 v54, 0
  v_mov_b32 v55, 0
  v_cndmask_b32 v48, 0, v48, vcc
  v_cndmask_b32 v49, 0, v49, vcc
  v_cndmask_b32 v52, 0, v52, vcc
  v_cndmask_b32 v53, 0, v53, vcc
  v_and_b32 v2, 15, v1
  v_lshrrev_b32 v3, 4, v1
  v_mul_u32_u24 v4, 80, v2
  v_lshlrev_b32 v5, 4, v3
  v_add_u32 v4, v4, v5
  v_add_u32 v4, 104448, v4
  v_and_b32 v6, 1, v2
  v_mul_u32_u24 v6, 80, v6
  v_add_u32 v6, v6, v5
  v_add_u32 v6, 107328, v6
  v_lshlrev_b32 v8, 4, v1
  v_mov_b32 v2, 107764
  s_mov_b32 s66, 0
L_wtbl_24:
  ds_read_b32 v3, v2
  s_waitcnt lgkmcnt(0)
  v_readfirstlane_b32 s12, v3
  s_add_u32 s66, s66, 1
  s_cmp_gt_u32 s66, 1048576
  s_cbranch_scc1 L_wtbld_25
  s_cmp_ge_u32 s12, 3
  s_cbranch_scc1 L_wtbld_25

  s_branch L_wtbl_24
L_wtbld_25:
  ds_read_b128 v[56:59], v4
  ds_read_b128 v[76:79], v6
  ds_read_b128 v[80:83], v6 offset:64
  ds_read_b128 v[60:63], v4 offset:1280
  ds_read_b128 v[64:67], v4 offset:1344
  ds_read_b128 v[68:71], v4 offset:2560
  ds_read_b128 v[72:75], v4 offset:2624
  s_waitcnt lgkmcnt(0)
  v_mfma_f32_16x16x32_bf16 v[124:127], v[76:79], v[40:43], 0
  v_mfma_f32_16x16x32_bf16 v[140:143], v[76:79], v[44:47], 0
  v_mfma_f32_16x16x32_bf16 v[124:127], v[80:83], v[48:51], v[124:127]
  v_mfma_f32_16x16x32_bf16 v[140:143], v[80:83], v[52:55], v[140:143]
  v_mfma_f32_16x16x32_bf16 v[112:115], v[56:59], v[40:43], 0
  v_mfma_f32_16x16x32_bf16 v[116:119], v[60:63], v[40:43], 0
  v_mfma_f32_16x16x32_bf16 v[120:123], v[68:71], v[40:43], 0
  v_mfma_f32_16x16x32_bf16 v[116:119], v[64:67], v[48:51], v[116:119]
  v_mfma_f32_16x16x32_bf16 v[120:123], v[72:75], v[48:51], v[120:123]
  v_mfma_f32_16x16x32_bf16 v[128:131], v[56:59], v[44:47], 0
  v_mfma_f32_16x16x32_bf16 v[132:135], v[60:63], v[44:47], 0
  v_mfma_f32_16x16x32_bf16 v[136:139], v[68:71], v[44:47], 0
  v_mfma_f32_16x16x32_bf16 v[132:135], v[64:67], v[52:55], v[132:135]
  v_mfma_f32_16x16x32_bf16 v[136:139], v[72:75], v[52:55], v[136:139]
  v_cmp_gt_u32 vcc, 16, v1
  v_add_f32 v124, 0x358637bd, v124
  v_add_f32 v125, 0x358637bd, v125
  v_add_f32 v140, 0x358637bd, v140
  v_add_f32 v141, 0x358637bd, v141
  v_rcp_f32 v124, v124
  v_rcp_f32 v125, v125
  v_rcp_f32 v140, v140
  v_rcp_f32 v141, v141
  s_nop 0
  v_cndmask_b32 v126, v125, v124, vcc
  v_cndmask_b32 v142, v141, v140, vcc
  v_mul_f32 v112, v112, v124
  v_mul_f32 v113, v113, v124
  v_mul_f32 v114, v114, v124
  v_mul_f32 v115, v115, v124
  v_mul_f32 v116, v116, v126
  v_mul_f32 v117, v117, v126
  v_mul_f32 v118, v118, v125
  v_mul_f32 v119, v119, v125
  v_cvt_pk_bf16_f32 v144, v112, v113
  v_cvt_pk_bf16_f32 v145, v114, v115
  v_cvt_pk_bf16_f32 v146, v116, v117
  v_cvt_pk_bf16_f32 v147, v118, v119
  v_min_u32 v144, -2, v144
  v_min_u32 v145, -2, v145
  v_min_u32 v146, -2, v146
  v_min_u32 v147, -2, v147
  buffer_store_dwordx4 v[144:147], v8, s[32:35], s58 offen sc1
  v_mul_f32 v128, v128, v140
  v_mul_f32 v129, v129, v140
  v_mul_f32 v130, v130, v140
  v_mul_f32 v131, v131, v140
  v_mul_f32 v132, v132, v142
  v_mul_f32 v133, v133, v142
  v_mul_f32 v134, v134, v141
  v_mul_f32 v135, v135, v141
  v_cvt_pk_bf16_f32 v152, v128, v129
  v_cvt_pk_bf16_f32 v153, v130, v131
  v_cvt_pk_bf16_f32 v154, v132, v133
  v_cvt_pk_bf16_f32 v155, v134, v135
  v_min_u32 v152, -2, v152
  v_min_u32 v153, -2, v153
  v_min_u32 v154, -2, v154
  v_min_u32 v155, -2, v155
  s_add_u32 s46, s58, 16384
  buffer_store_dwordx4 v[152:155], v8, s[32:35], s46 offen sc1
  v_mul_f32 v120, v120, v125
  v_mul_f32 v121, v121, v125
  v_mul_f32 v122, v122, v125
  v_mul_f32 v123, v123, v125
  v_cvt_pk_bf16_f32 v148, v120, v121
  v_cvt_pk_bf16_f32 v149, v122, v123
  v_min_u32 v148, -2, v148
  v_min_u32 v149, -2, v149
  v_mul_f32 v136, v136, v141
  v_mul_f32 v137, v137, v141
  v_mul_f32 v138, v138, v141
  v_mul_f32 v139, v139, v141
  v_cvt_pk_bf16_f32 v156, v136, v137
  v_cvt_pk_bf16_f32 v157, v138, v139
  v_min_u32 v156, -2, v156
  v_min_u32 v157, -2, v157
  v_lshlrev_b32 v7, 3, v1
  s_nop 0
  v_permlane16_swap_b32 v148, v156
  v_permlane16_swap_b32 v149, v157
  s_mov_b32 exec_hi, 0
  buffer_store_dwordx2 v[148:149], v7, s[32:35], s59 offen sc1
  s_mov_b32 exec_hi, -1
  s_lshl_b32 s46, s36, 2
  s_add_u32 s46, s46, s45
  s_lshl_b32 s46, s46, 4
  s_add_u32 s46, s46, s37
  s_lshl_b32 s46, s46, 6
  s_add_u32 s46, s46, 3538944
  v_mov_b32 v152, s41
  v_mov_b32 v153, s41
  v_mov_b32 v154, s41
  v_mov_b32 v155, s41
  s_mov_b64 exec, 0xf
  buffer_store_dwordx4 v[152:155], v8, s[32:35], s46 offen sc1
  s_mov_b64 exec, -1
  s_lshl_b32 s46, s36, 3
  s_and_b32 s47, s37, 1
  s_lshl_b32 s47, s47, 2
  s_add_u32 s47, s47, s45
  s_add_u32 s56, s46, s47
  s_lshr_b32 s48, s47, 1
  s_lshl_b32 s46, s36, 2
  s_add_u32 s46, s46, s48
  s_lshl_b32 s46, s46, 10
  s_add_u32 s57, s46, 3538944
  s_lshl_b32 s46, s36, 14
  s_lshl_b32 s47, s47, 7
  s_add_u32 s46, s46, s47
  s_add_u32 s61, s46, 3145728
  v_and_b32 v2, 15, v1
  v_lshrrev_b32 v3, 4, v1
  v_lshrrev_b32 v7, 2, v2
  v_and_b32 v5, 3, v1
  v_lshlrev_b32 v5, 3, v5
  v_lshlrev_b32 v10, 2, v3
  v_add_u32 v10, v10, v7
  v_mul_u32_u24 v10, 160, v10
  v_add_u32 v10, v10, v5
  v_add_u32 v11, 46080, v10
  v_mul_u32_u24 v12, 72, v3
  v_add_u32 v12, v12, v7
  v_add_u32 v12, 32, v12
  v_mul_u32_u24 v12, 160, v12
  v_add_u32 v12, v12, v5
  v_lshlrev_b32 v15, 6, v2
  v_lshlrev_b32 v13, 11, v3
  v_lshlrev_b32 v7, 3, v2
  v_add_u32 v13, v13, v7
  v_mul_u32_u24 v9, 1152, v2
  v_lshlrev_b32 v7, 3, v3
  v_add_u32 v9, v9, v7
  v_lshlrev_b32 v8, 4, v1
  s_lshl_b32 s46, s56, 14
  s_add_u32 s46, s46, 1048576
  s_mov_b32 s48, 0
  v_mov_b32 v6, 107768
  s_mov_b32 s66, 0
L_wwo1_28:
  ds_read_b32 v7, v6
  s_waitcnt lgkmcnt(0)
  v_readfirstlane_b32 s12, v7
  s_add_u32 s66, s66, 1
  s_cmp_gt_u32 s66, 1048576
  s_cbranch_scc1 L_wwo1d_29
  s_cmp_ge_u32 s12, 1
  s_cbranch_scc1 L_wwo1d_29

  s_branch L_wwo1_28
L_wwo1d_29:
  s_mov_b32 s66, 0
  ds_read_b64_tr_b16 v[16:17], v10 offset:0
  ds_read_b64_tr_b16 v[18:19], v10 offset:2560
  ds_read_b64_tr_b16 v[20:21], v10 offset:32
  ds_read_b64_tr_b16 v[22:23], v10 offset:2592
  ds_read_b64_tr_b16 v[24:25], v10 offset:64
  ds_read_b64_tr_b16 v[26:27], v10 offset:2624
  ds_read_b64_tr_b16 v[28:29], v10 offset:96
  ds_read_b64_tr_b16 v[30:31], v10 offset:2656
  ds_read_b64_tr_b16 v[32:33], v10 offset:128
  ds_read_b64_tr_b16 v[34:35], v10 offset:2688
  ds_read_b64_tr_b16 v[36:37], v10 offset:5760
  ds_read_b64_tr_b16 v[38:39], v10 offset:8320
  ds_read_b64_tr_b16 v[40:41], v10 offset:5792
  ds_read_b64_tr_b16 v[42:43], v10 offset:8352
  ds_read_b64_tr_b16 v[44:45], v10 offset:5824
  ds_read_b64_tr_b16 v[46:47], v10 offset:8384
  ds_read_b64_tr_b16 v[48:49], v10 offset:5856
  ds_read_b64_tr_b16 v[50:51], v10 offset:8416
  ds_read_b64_tr_b16 v[52:53], v10 offset:5888
  ds_read_b64_tr_b16 v[54:55], v10 offset:8448
  ds_read_b64_tr_b16 v[56:57], v10 offset:11520
  ds_read_b64_tr_b16 v[58:59], v10 offset:14080
  ds_read_b64_tr_b16 v[60:61], v10 offset:11552
  ds_read_b64_tr_b16 v[62:63], v10 offset:14112
  ds_read_b64_tr_b16 v[64:65], v10 offset:11584
  ds_read_b64_tr_b16 v[66:67], v10 offset:14144
  ds_read_b64_tr_b16 v[68:69], v10 offset:11616
  ds_read_b64_tr_b16 v[70:71], v10 offset:14176
  ds_read_b64_tr_b16 v[72:73], v10 offset:11648
  ds_read_b64_tr_b16 v[74:75], v10 offset:14208
  ds_read_b64_tr_b16 v[76:77], v10 offset:17280
  ds_read_b64_tr_b16 v[78:79], v10 offset:19840
  ds_read_b64_tr_b16 v[80:81], v10 offset:17312
  ds_read_b64_tr_b16 v[82:83], v10 offset:19872
  ds_read_b64_tr_b16 v[84:85], v10 offset:17344
  ds_read_b64_tr_b16 v[86:87], v10 offset:19904
  ds_read_b64_tr_b16 v[88:89], v10 offset:17376
  ds_read_b64_tr_b16 v[90:91], v10 offset:19936
  ds_read_b64_tr_b16 v[92:93], v10 offset:17408
  ds_read_b64_tr_b16 v[94:95], v10 offset:19968
  ds_read_b64_tr_b16 v[96:97], v10 offset:23040
  ds_read_b64_tr_b16 v[98:99], v10 offset:25600
  ds_read_b64_tr_b16 v[100:101], v10 offset:23072
  ds_read_b64_tr_b16 v[102:103], v10 offset:25632
  ds_read_b64_tr_b16 v[104:105], v10 offset:23104
  ds_read_b64_tr_b16 v[106:107], v10 offset:25664
  ds_read_b64_tr_b16 v[108:109], v10 offset:23136
  ds_read_b64_tr_b16 v[110:111], v10 offset:25696
  ds_read_b64_tr_b16 v[112:113], v10 offset:23168
  ds_read_b64_tr_b16 v[114:115], v10 offset:25728
  ds_read_b64_tr_b16 v[116:117], v10 offset:28800
  ds_read_b64_tr_b16 v[118:119], v10 offset:31360
  ds_read_b64_tr_b16 v[120:121], v10 offset:28832
  ds_read_b64_tr_b16 v[122:123], v10 offset:31392
  ds_read_b64_tr_b16 v[124:125], v10 offset:28864
  ds_read_b64_tr_b16 v[126:127], v10 offset:31424
  ds_read_b64_tr_b16 v[128:129], v10 offset:28896
  ds_read_b64_tr_b16 v[130:131], v10 offset:31456
  ds_read_b64_tr_b16 v[132:133], v10 offset:28928
  ds_read_b64_tr_b16 v[134:135], v10 offset:31488
  ds_read_b64_tr_b16 v[136:137], v10 offset:34560
  ds_read_b64_tr_b16 v[138:139], v10 offset:37120
  ds_read_b64_tr_b16 v[140:141], v10 offset:34592
  ds_read_b64_tr_b16 v[142:143], v10 offset:37152
  ds_read_b64_tr_b16 v[144:145], v10 offset:34624
  ds_read_b64_tr_b16 v[146:147], v10 offset:37184
  ds_read_b64_tr_b16 v[148:149], v10 offset:34656
  ds_read_b64_tr_b16 v[150:151], v10 offset:37216
  ds_read_b64_tr_b16 v[152:153], v10 offset:34688
  ds_read_b64_tr_b16 v[154:155], v10 offset:37248
  ds_read_b64_tr_b16 v[156:157], v10 offset:40320
  ds_read_b64_tr_b16 v[158:159], v10 offset:42880
  ds_read_b64_tr_b16 v[160:161], v10 offset:40352
  ds_read_b64_tr_b16 v[162:163], v10 offset:42912
  ds_read_b64_tr_b16 v[164:165], v10 offset:40384
  ds_read_b64_tr_b16 v[166:167], v10 offset:42944
  ds_read_b64_tr_b16 v[168:169], v10 offset:40416
  ds_read_b64_tr_b16 v[170:171], v10 offset:42976
  ds_read_b64_tr_b16 v[172:173], v10 offset:40448
  ds_read_b64_tr_b16 v[174:175], v10 offset:43008
  ds_read_b64_tr_b16 v[176:177], v11 offset:0
  ds_read_b64_tr_b16 v[178:179], v11 offset:2560
  ds_read_b64_tr_b16 v[180:181], v11 offset:32
  ds_read_b64_tr_b16 v[182:183], v11 offset:2592
  ds_read_b64_tr_b16 v[184:185], v11 offset:64
  ds_read_b64_tr_b16 v[186:187], v11 offset:2624
  ds_read_b64_tr_b16 v[188:189], v11 offset:96
  ds_read_b64_tr_b16 v[190:191], v11 offset:2656
  ds_read_b64_tr_b16 v[192:193], v11 offset:128
  ds_read_b64_tr_b16 v[194:195], v11 offset:2688
L_oh_30:
  buffer_load_dword v2, v15, s[32:35], s57 offen sc1
  s_waitcnt vmcnt(0)
  v_cmp_ne_u32 vcc, s41, v2
  s_cbranch_vccz L_ohd_31
  s_sleep 2
  s_add_u32 s66, s66, 1
  s_cmp_gt_u32 s66, 1048576
  s_cbranch_scc0 L_oh_30
L_ohd_31:
  s_or_b32 s49, s36, s37
  s_or_b32 s49, s49, s45
  s_cmp_lg_u32 s49, 0
  s_cbranch_scc1 L_noepoch
  s_add_u32 s49, s42, 1
  v_mov_b32 v6, s49
  v_mov_b32 v7, 0
  s_mov_b64 exec, 1
  buffer_store_dword v6, v7, s[32:35], 0 offen sc1
  s_mov_b64 exec, -1
L_noepoch:
  s_barrier
  s_add_u32 s47, s46, 0
  buffer_load_dwordx4 v[196:199], v8, s[32:35], s47 offen offset:0
  buffer_load_dwordx4 v[200:203], v8, s[32:35], s47 offen offset:1024
  buffer_load_dwordx4 v[204:207], v8, s[32:35], s47 offen offset:2048
  buffer_load_dwordx4 v[208:211], v8, s[32:35], s47 offen offset:3072
  s_add_u32 s47, s46, 4096
  buffer_load_dwordx4 v[212:215], v8, s[32:35], s47 offen offset:0
  buffer_load_dwordx4 v[216:219], v8, s[32:35], s47 offen offset:1024
  buffer_load_dwordx4 v[220:223], v8, s[32:35], s47 offen offset:2048
  buffer_load_dwordx4 v[224:227], v8, s[32:35], s47 offen offset:3072
  s_add_u32 s47, s46, 8192
  buffer_load_dwordx4 v[228:231], v8, s[32:35], s47 offen offset:0
  s_waitcnt vmcnt(8) lgkmcnt(0)
  v_mfma_f32_16x16x32_bf16 v[232:235], v[16:19], v[196:199], 0
  v_mfma_f32_16x16x32_bf16 v[236:239], v[20:23], v[196:199], 0
  v_max3_u32 v5, v196, v197, v198
  v_max_u32 v5, v5, v199
  v_mfma_f32_16x16x32_bf16 v[240:243], v[24:27], v[196:199], 0
  v_mfma_f32_16x16x32_bf16 v[244:247], v[28:31], v[196:199], 0
  v_mfma_f32_16x16x32_bf16 v[248:251], v[32:35], v[196:199], 0
  s_waitcnt vmcnt(7)
  v_mfma_f32_16x16x32_bf16 v[232:235], v[36:39], v[200:203], v[232:235]
  v_mfma_f32_16x16x32_bf16 v[236:239], v[40:43], v[200:203], v[236:239]
  v_max3_u32 v5, v5, v200, v201
  v_max3_u32 v5, v5, v202, v203
  v_mfma_f32_16x16x32_bf16 v[240:243], v[44:47], v[200:203], v[240:243]
  v_mfma_f32_16x16x32_bf16 v[244:247], v[48:51], v[200:203], v[244:247]
  v_mfma_f32_16x16x32_bf16 v[248:251], v[52:55], v[200:203], v[248:251]
  s_waitcnt vmcnt(6)
  v_mfma_f32_16x16x32_bf16 v[232:235], v[56:59], v[204:207], v[232:235]
  v_mfma_f32_16x16x32_bf16 v[236:239], v[60:63], v[204:207], v[236:239]
  v_max3_u32 v5, v5, v204, v205
  v_max3_u32 v5, v5, v206, v207
  v_mfma_f32_16x16x32_bf16 v[240:243], v[64:67], v[204:207], v[240:243]
  v_mfma_f32_16x16x32_bf16 v[244:247], v[68:71], v[204:207], v[244:247]
  v_mfma_f32_16x16x32_bf16 v[248:251], v[72:75], v[204:207], v[248:251]
  s_waitcnt vmcnt(5)
  v_mfma_f32_16x16x32_bf16 v[232:235], v[76:79], v[208:211], v[232:235]
  v_mfma_f32_16x16x32_bf16 v[236:239], v[80:83], v[208:211], v[236:239]
  v_max3_u32 v5, v5, v208, v209
  v_max3_u32 v5, v5, v210, v211
  v_mfma_f32_16x16x32_bf16 v[240:243], v[84:87], v[208:211], v[240:243]
  v_mfma_f32_16x16x32_bf16 v[244:247], v[88:91], v[208:211], v[244:247]
  v_mfma_f32_16x16x32_bf16 v[248:251], v[92:95], v[208:211], v[248:251]
  s_waitcnt vmcnt(4)
  v_mfma_f32_16x16x32_bf16 v[232:235], v[96:99], v[212:215], v[232:235]
  v_mfma_f32_16x16x32_bf16 v[236:239], v[100:103], v[212:215], v[236:239]
  v_max3_u32 v5, v5, v212, v213
  v_max3_u32 v5, v5, v214, v215
  v_mfma_f32_16x16x32_bf16 v[240:243], v[104:107], v[212:215], v[240:243]
  v_mfma_f32_16x16x32_bf16 v[244:247], v[108:111], v[212:215], v[244:247]
  v_mfma_f32_16x16x32_bf16 v[248:251], v[112:115], v[212:215], v[248:251]
  s_waitcnt vmcnt(3)
  v_mfma_f32_16x16x32_bf16 v[232:235], v[116:119], v[216:219], v[232:235]
  v_mfma_f32_16x16x32_bf16 v[236:239], v[120:123], v[216:219], v[236:239]
  v_max3_u32 v5, v5, v216, v217
  v_max3_u32 v5, v5, v218, v219
  v_mfma_f32_16x16x32_bf16 v[240:243], v[124:127], v[216:219], v[240:243]
  v_mfma_f32_16x16x32_bf16 v[244:247], v[128:131], v[216:219], v[244:247]
  v_mfma_f32_16x16x32_bf16 v[248:251], v[132:135], v[216:219], v[248:251]
  s_waitcnt vmcnt(2)
  v_mfma_f32_16x16x32_bf16 v[232:235], v[136:139], v[220:223], v[232:235]
  v_mfma_f32_16x16x32_bf16 v[236:239], v[140:143], v[220:223], v[236:239]
  v_max3_u32 v5, v5, v220, v221
  v_max3_u32 v5, v5, v222, v223
  v_mfma_f32_16x16x32_bf16 v[240:243], v[144:147], v[220:223], v[240:243]
  v_mfma_f32_16x16x32_bf16 v[244:247], v[148:151], v[220:223], v[244:247]
  v_mfma_f32_16x16x32_bf16 v[248:251], v[152:155], v[220:223], v[248:251]
  s_waitcnt vmcnt(1)
  v_mfma_f32_16x16x32_bf16 v[232:235], v[156:159], v[224:227], v[232:235]
  v_mfma_f32_16x16x32_bf16 v[236:239], v[160:163], v[224:227], v[236:239]
  v_max3_u32 v5, v5, v224, v225
  v_max3_u32 v5, v5, v226, v227
  v_mfma_f32_16x16x32_bf16 v[240:243], v[164:167], v[224:227], v[240:243]
  v_mfma_f32_16x16x32_bf16 v[244:247], v[168:171], v[224:227], v[244:247]
  v_mfma_f32_16x16x32_bf16 v[248:251], v[172:175], v[224:227], v[248:251]
  s_waitcnt vmcnt(0)
  v_mfma_f32_16x16x32_bf16 v[232:235], v[176:179], v[228:231], v[232:235]
  v_mfma_f32_16x16x32_bf16 v[236:239], v[180:183], v[228:231], v[236:239]
  v_max3_u32 v5, v5, v228, v229
  v_max3_u32 v5, v5, v230, v231
  v_mfma_f32_16x16x32_bf16 v[240:243], v[184:187], v[228:231], v[240:243]
  v_mfma_f32_16x16x32_bf16 v[244:247], v[188:191], v[228:231], v[244:247]
  v_mfma_f32_16x16x32_bf16 v[248:251], v[192:195], v[228:231], v[248:251]
  v_cmp_eq_u32 vcc, -1, v5
  s_cbranch_vccz L_opd_27
L_op_26:
  s_nop 7
  s_add_u32 s48, s48, 1
  s_add_u32 s47, s46, 0
  buffer_load_dwordx4 v[196:199], v8, s[32:35], s47 offen offset:0 sc1
  buffer_load_dwordx4 v[200:203], v8, s[32:35], s47 offen offset:1024 sc1
  buffer_load_dwordx4 v[204:207], v8, s[32:35], s47 offen offset:2048 sc1
  buffer_load_dwordx4 v[208:211], v8, s[32:35], s47 offen offset:3072 sc1
  s_add_u32 s47, s46, 4096
  buffer_load_dwordx4 v[212:215], v8, s[32:35], s47 offen offset:0 sc1
  buffer_load_dwordx4 v[216:219], v8, s[32:35], s47 offen offset:1024 sc1
  buffer_load_dwordx4 v[220:223], v8, s[32:35], s47 offen offset:2048 sc1
  buffer_load_dwordx4 v[224:227], v8, s[32:35], s47 offen offset:3072 sc1
  s_add_u32 s47, s46, 8192
  buffer_load_dwordx4 v[228:231], v8, s[32:35], s47 offen offset:0 sc1
  s_waitcnt vmcnt(8) lgkmcnt(0)
  v_mfma_f32_16x16x32_bf16 v[232:235], v[16:19], v[196:199], 0
  v_mfma_f32_16x16x32_bf16 v[236:239], v[20:23], v[196:199], 0
  v_max3_u32 v5, v196, v197, v198
  v_max_u32 v5, v5, v199
  v_mfma_f32_16x16x32_bf16 v[240:243], v[24:27], v[196:199], 0
  v_mfma_f32_16x16x32_bf16 v[244:247], v[28:31], v[196:199], 0
  v_mfma_f32_16x16x32_bf16 v[248:251], v[32:35], v[196:199], 0
  s_waitcnt vmcnt(7)
  v_mfma_f32_16x16x32_bf16 v[232:235], v[36:39], v[200:203], v[232:235]
  v_mfma_f32_16x16x32_bf16 v[236:239], v[40:43], v[200:203], v[236:239]
  v_max3_u32 v5, v5, v200, v201
  v_max3_u32 v5, v5, v202, v203
  v_mfma_f32_16x16x32_bf16 v[240:243], v[44:47], v[200:203], v[240:243]
  v_mfma_f32_16x16x32_bf16 v[244:247], v[48:51], v[200:203], v[244:247]
  v_mfma_f32_16x16x32_bf16 v[248:251], v[52:55], v[200:203], v[248:251]
  s_waitcnt vmcnt(6)
  v_mfma_f32_16x16x32_bf16 v[232:235], v[56:59], v[204:207], v[232:235]
  v_mfma_f32_16x16x32_bf16 v[236:239], v[60:63], v[204:207], v[236:239]
  v_max3_u32 v5, v5, v204, v205
  v_max3_u32 v5, v5, v206, v207
  v_mfma_f32_16x16x32_bf16 v[240:243], v[64:67], v[204:207], v[240:243]
  v_mfma_f32_16x16x32_bf16 v[244:247], v[68:71], v[204:207], v[244:247]
  v_mfma_f32_16x16x32_bf16 v[248:251], v[72:75], v[204:207], v[248:251]
  s_waitcnt vmcnt(5)
  v_mfma_f32_16x16x32_bf16 v[232:235], v[76:79], v[208:211], v[232:235]
  v_mfma_f32_16x16x32_bf16 v[236:239], v[80:83], v[208:211], v[236:239]
  v_max3_u32 v5, v5, v208, v209
  v_max3_u32 v5, v5, v210, v211
  v_mfma_f32_16x16x32_bf16 v[240:243], v[84:87], v[208:211], v[240:243]
  v_mfma_f32_16x16x32_bf16 v[244:247], v[88:91], v[208:211], v[244:247]
  v_mfma_f32_16x16x32_bf16 v[248:251], v[92:95], v[208:211], v[248:251]
  s_waitcnt vmcnt(4)
  v_mfma_f32_16x16x32_bf16 v[232:235], v[96:99], v[212:215], v[232:235]
  v_mfma_f32_16x16x32_bf16 v[236:239], v[100:103], v[212:215], v[236:239]
  v_max3_u32 v5, v5, v212, v213
  v_max3_u32 v5, v5, v214, v215
  v_mfma_f32_16x16x32_bf16 v[240:243], v[104:107], v[212:215], v[240:243]
  v_mfma_f32_16x16x32_bf16 v[244:247], v[108:111], v[212:215], v[244:247]
  v_mfma_f32_16x16x32_bf16 v[248:251], v[112:115], v[212:215], v[248:251]
  s_waitcnt vmcnt(3)
  v_mfma_f32_16x16x32_bf16 v[232:235], v[116:119], v[216:219], v[232:235]
  v_mfma_f32_16x16x32_bf16 v[236:239], v[120:123], v[216:219], v[236:239]
  v_max3_u32 v5, v5, v216, v217
  v_max3_u32 v5, v5, v218, v219
  v_mfma_f32_16x16x32_bf16 v[240:243], v[124:127], v[216:219], v[240:243]
  v_mfma_f32_16x16x32_bf16 v[244:247], v[128:131], v[216:219], v[244:247]
  v_mfma_f32_16x16x32_bf16 v[248:251], v[132:135], v[216:219], v[248:251]
  s_waitcnt vmcnt(2)
  v_mfma_f32_16x16x32_bf16 v[232:235], v[136:139], v[220:223], v[232:235]
  v_mfma_f32_16x16x32_bf16 v[236:239], v[140:143], v[220:223], v[236:239]
  v_max3_u32 v5, v5, v220, v221
  v_max3_u32 v5, v5, v222, v223
  v_mfma_f32_16x16x32_bf16 v[240:243], v[144:147], v[220:223], v[240:243]
  v_mfma_f32_16x16x32_bf16 v[244:247], v[148:151], v[220:223], v[244:247]
  v_mfma_f32_16x16x32_bf16 v[248:251], v[152:155], v[220:223], v[248:251]
  s_waitcnt vmcnt(1)
  v_mfma_f32_16x16x32_bf16 v[232:235], v[156:159], v[224:227], v[232:235]
  v_mfma_f32_16x16x32_bf16 v[236:239], v[160:163], v[224:227], v[236:239]
  v_max3_u32 v5, v5, v224, v225
  v_max3_u32 v5, v5, v226, v227
  v_mfma_f32_16x16x32_bf16 v[240:243], v[164:167], v[224:227], v[240:243]
  v_mfma_f32_16x16x32_bf16 v[244:247], v[168:171], v[224:227], v[244:247]
  v_mfma_f32_16x16x32_bf16 v[248:251], v[172:175], v[224:227], v[248:251]
  s_waitcnt vmcnt(0)
  v_mfma_f32_16x16x32_bf16 v[232:235], v[176:179], v[228:231], v[232:235]
  v_mfma_f32_16x16x32_bf16 v[236:239], v[180:183], v[228:231], v[236:239]
  v_max3_u32 v5, v5, v228, v229
  v_max3_u32 v5, v5, v230, v231
  v_mfma_f32_16x16x32_bf16 v[240:243], v[184:187], v[228:231], v[240:243]
  v_mfma_f32_16x16x32_bf16 v[244:247], v[188:191], v[228:231], v[244:247]
  v_mfma_f32_16x16x32_bf16 v[248:251], v[192:195], v[228:231], v[248:251]
  v_cmp_eq_u32 vcc, -1, v5
  s_cbranch_vccz L_opd_27
  s_cmp_gt_u32 s48, 1048576
  s_cbranch_scc0 L_op_26
L_opd_27:
  s_mul_i32 s49, s45, 5120
  s_add_u32 s49, s49, 113152
  v_add_u32 v6, s49, v8
  s_lshl_b32 s49, s45, 2
  s_add_u32 s49, s49, 107788
  s_mul_i32 s50, s45, 5120
  s_add_u32 s50, s50, 113152
  v_add_u32 v6, s50, v8
  s_lshl_b32 s50, s45, 2
  s_add_u32 s50, s50, 107788
  v_mov_b32 v2, s50
  s_mov_b32 s66, 0
L_lp_33:
  ds_read_b32 v3, v2
  s_waitcnt lgkmcnt(0)
  v_readfirstlane_b32 s12, v3
  s_add_u32 s66, s66, 1
  s_cmp_gt_u32 s66, 1048576
  s_cbranch_scc1 L_lpd_34
  s_cmp_eq_u32 s12, 0
  s_cbranch_scc1 L_lp_33
L_lpd_34:
  ds_read_b128 v[196:199], v6 offset:0
  ds_read_b128 v[200:203], v6 offset:1024
  ds_read_b128 v[204:207], v6 offset:2048
  ds_read_b128 v[208:211], v6 offset:3072
  ds_read_b128 v[212:215], v6 offset:4096
L_lpskip_32:
  s_lshl_b32 s46, s56, 4
  s_mul_i32 s46, s46, 1152
  s_lshr_b32 s47, s37, 1
  s_mul_i32 s47, s47, 144
  s_add_u32 s46, s46, s47
  v_lshrrev_b32 v7, 4, v1
  v_lshlrev_b32 v7, 3, v7
  v_add_u32 v7, v9, v7
  s_waitcnt lgkmcnt(4)
  v_pk_add_f32 v[232:233], v[232:233], v[196:197]
  v_pk_add_f32 v[234:235], v[234:235], v[198:199]
  v_cvt_pk_bf16_f32 v40, v232, v233
  v_cvt_pk_bf16_f32 v41, v234, v235
  s_waitcnt lgkmcnt(3)
  v_pk_add_f32 v[236:237], v[236:237], v[200:201]
  v_pk_add_f32 v[238:239], v[238:239], v[202:203]
  v_cvt_pk_bf16_f32 v42, v236, v237
  v_cvt_pk_bf16_f32 v43, v238, v239
  s_nop 1
  v_permlane32_swap_b32 v40, v42
  v_permlane32_swap_b32 v41, v43
  s_nop 1
  v_permlane16_swap_b32 v40, v42
  v_permlane16_swap_b32 v41, v43
  buffer_store_dwordx4 v[40:43], v7, s[28:31], s46 offen offset:0
  s_waitcnt lgkmcnt(2)
  v_pk_add_f32 v[240:241], v[240:241], v[204:205]
  v_pk_add_f32 v[242:243], v[242:243], v[206:207]
  v_cvt_pk_bf16_f32 v44, v240, v241
  v_cvt_pk_bf16_f32 v45, v242, v243
  s_waitcnt lgkmcnt(1)
  v_pk_add_f32 v[244:245], v[244:245], v[208:209]
  v_pk_add_f32 v[246:247], v[246:247], v[210:211]
  v_cvt_pk_bf16_f32 v46, v244, v245
  v_cvt_pk_bf16_f32 v47, v246, v247
  s_nop 1
  v_permlane32_swap_b32 v44, v46
  v_permlane32_swap_b32 v45, v47
  s_nop 1
  v_permlane16_swap_b32 v44, v46
  v_permlane16_swap_b32 v45, v47
  buffer_store_dwordx4 v[44:47], v7, s[28:31], s46 offen offset:64
  s_waitcnt lgkmcnt(0)
  v_pk_add_f32 v[248:249], v[248:249], v[212:213]
  v_pk_add_f32 v[250:251], v[250:251], v[214:215]
  v_cvt_pk_bf16_f32 v48, v248, v249
  v_cvt_pk_bf16_f32 v49, v250, v251
  s_mov_b32 exec_hi, 0
  buffer_store_dwordx2 v[48:49], v9, s[28:31], s46 offen offset:128
  s_mov_b32 exec_hi, -1
  s_endpgm
L_end:
  s_endpgm
.section .rodata,"a"
.p2align 6
.amdhsa_kernel standalone__linear_attn_block__prompt_kernel
  .amdhsa_next_free_vgpr 256
  .amdhsa_next_free_sgpr 102
  .amdhsa_accum_offset 256
  .amdhsa_group_segment_fixed_size 0
  .amdhsa_kernarg_size 48
  .amdhsa_user_sgpr_count 2
  .amdhsa_user_sgpr_kernarg_segment_ptr 1
  .amdhsa_system_sgpr_workgroup_id_x 1
  .amdhsa_float_denorm_mode_32 3
.end_amdhsa_kernel
```
